```python
import torch

def _softmax(x, axis=-1):
    return torch.softmax(x, dim=axis)

def _gelu(x):
    return torch.nn.functional.gelu(x, approximate='tanh')

def _silu(x):
    return torch.nn.functional.silu(x)

def _sigmoid(x):
    return torch.sigmoid(x)

def _layernorm(x, axis=-1, eps=1e-05):
    m = x.mean(dim=axis, keepdim=True)
    v = x.var(dim=axis, keepdim=True, unbiased=False)
    return (x - m) / torch.sqrt(v + eps)

def _scatter_add(tgt, idx, src, axis=0):
    return tgt.clone().index_add_(axis, idx, src)

def _segment_sum(src, seg, n):
    out = torch.zeros((n,) + src.shape[1:], dtype=src.dtype)
    return out.index_add_(0, seg, src)

def _pad(x, pw):
    flat = tuple((v for pair in reversed(pw) for v in pair))
    return torch.nn.functional.pad(x, flat)
kernel_name = 'adaLN_cond__grouped_kv_mqa__swiglu_ffn__prompt'

def setup_inputs():

    _w = lambda a: (lambda t: t.to(torch.bfloat16) if t.is_floating_point() else t)(torch.as_tensor(a))

    def _A_setup():
        B, S, D, H = (1, 2048, 576, 32)
        Dh = D // H
        return {'x': _w((lambda *s: torch.randn(*s, dtype=torch.bfloat16) * 0.05)(B, S, D)), 'wq': _w((lambda *s: torch.randn(*s, dtype=torch.bfloat16) * 0.05)(D, H * Dh)), 'wk': _w((lambda *s: torch.randn(*s, dtype=torch.bfloat16) * 0.05)(D, Dh)), 'wv': _w((lambda *s: torch.randn(*s, dtype=torch.bfloat16) * 0.05)(D, Dh)), 'wo': _w((lambda *s: torch.randn(*s, dtype=torch.bfloat16) * 0.05)(H * Dh, D))}
    _A_in = _A_setup()

    def _B_setup():
        B, S, D, F = (1, 2048, 576, 4608)
        return {'x': _w((lambda *s: torch.randn(*s, dtype=torch.bfloat16) * 0.05)(B, S, D)), 'w_gate': _w((lambda *s: torch.randn(*s, dtype=torch.bfloat16) * 0.05)(D, F)), 'w_up': _w((lambda *s: torch.randn(*s, dtype=torch.bfloat16) * 0.05)(D, F)), 'w_down': _w((lambda *s: torch.randn(*s, dtype=torch.bfloat16) * 0.05)(F, D))}
    _B_in = _B_setup()
    return {'A_x': _A_in['x'], 'A_wq': _A_in['wq'], 'A_wk': _A_in['wk'], 'A_wv': _A_in['wv'], 'A_wo': _A_in['wo'], 'B_x': _B_in['x'], 'B_w_gate': _B_in['w_gate'], 'B_w_up': _B_in['w_up'], 'B_w_down': _B_in['w_down'], 'c': _w((lambda *s: torch.randn(*s, dtype=torch.bfloat16) * 0.1)(1, 576) * 8.0), 'w_mod': _w((lambda *s: torch.randn(*s, dtype=torch.bfloat16) * 0.1)(576, 6 * 576) * 576 ** (-0.5) * 8.0)}

def reference(A_x, A_wq, A_wk, A_wv, A_wo, B_x, B_w_gate, B_w_up, B_w_down, c, w_mod):

    def _A_ref(x, wq, wk, wv, wo):
        B, S, D = x.shape
        H = 32
        Dh = D // H
        q = (lambda x, *d: x.permute(*d))((x @ wq).reshape(B, S, H, Dh), 0, 2, 1, 3)
        k = x @ wk
        v = x @ wv
        scores = torch.einsum('bhqd,bkd->bhqk', q, k) * Dh ** (-0.5)
        p = _softmax(scores, axis=-1)
        o = torch.einsum('bhqk,bkd->bhqd', p, v)
        return (lambda x, *d: x.permute(*d))(o, 0, 2, 1, 3).reshape(B, S, H * Dh) @ wo

    def _B_ref(x, w_gate, w_up, w_down):
        g = _silu(x @ w_gate)
        u = x @ w_up
        return g * u @ w_down
    x = A_x
    mod = (_silu(c) @ w_mod).reshape(c.shape[0], 6, 1, -1)
    sa, ca, ga, sb, cb, gb = (mod[:, 0].clone(), mod[:, 1].clone(), mod[:, 2].clone(), mod[:, 3].clone(), mod[:, 4].clone(), mod[:, 5].clone())
    h = _layernorm(x, axis=-1) * (1 + ca) + sa
    x = x + ga * _A_ref(h, A_wq, A_wk, A_wv, A_wo)
    h = _layernorm(x, axis=-1) * (1 + cb) + sb
    x = x + gb * _B_ref(h, B_w_gate, B_w_up, B_w_down)
    return x
```

```asm
; @launch kernel=prep_kernel grid=(630,1,1) block=(256,1,1) lds=1024
; @launch kernel=qkv_kernel grid=(256,1,1) block=(576,1,1) lds=79872
; @launch kernel=attn_kernel grid=(256,1,1) block=(512,1,1) lds=163840
; @launch kernel=wo_kernel grid=(256,1,1) block=(576,1,1) lds=46080
; @launch kernel=ffn1_kernel grid=(256,1,1) block=(768,1,1) lds=159744
; @launch kernel=ffn2_kernel grid=(256,1,1) block=(768,1,1) lds=147456
.amdgcn_target "amdgcn-amd-amdhsa--gfx950"
.text
.globl prep_kernel
.p2align 8
.type prep_kernel,@function
prep_kernel:
  s_load_dwordx4 s[44:47], s[0:1], 48
  s_load_dwordx8 s[4:11], s[0:1], 0
  s_load_dwordx2 s[12:13], s[0:1], 32
  s_load_dwordx4 s[16:19], s[0:1], 72
  s_load_dwordx2 s[20:21], s[0:1], 104
  v_and_b32 v1, 63, v0
  v_lshrrev_b32 v2, 6, v0
  s_nop 0
  v_readfirstlane_b32 s3, v2
  s_cmp_ge_u32 s2, 630
  s_cbranch_scc1 L_k1_end
  s_waitcnt lgkmcnt(0)
  s_cmp_ge_u32 s2, 630
  s_cbranch_scc1 L_k1_warm
  s_cmp_lt_u32 s2, 64
  s_cbranch_scc1 L_k1_ln
  s_sub_u32 s2, s2, 64
  s_cmp_ge_u32 s2, 224
  s_cbranch_scc1 L_k1_pack
  s_and_b32 s22, s2, 7
  s_lshr_b32 s23, s2, 3
  s_and_b32 s23, s23, 3
  s_lshr_b32 s24, s2, 5
  s_lshl_b32 s24, s24, 3
  s_add_u32 s24, s24, s22
  s_cmp_ge_u32 s24, 54
  s_cbranch_scc1 L_k1_end
  s_lshl_b32 s24, s24, 2
  s_add_u32 s24, s24, s23
  s_lshl_b32 s25, s24, 4
  s_mov_b32 s28, s18
  s_mov_b32 s29, s19
  s_mov_b32 s30, 3981312
  s_mov_b32 s31, 0x20000
  s_mov_b32 s32, s16
  s_mov_b32 s33, s17
  s_mov_b32 s34, 1152
  s_mov_b32 s35, 0x20000
  s_mov_b32 s36, s20
  s_mov_b32 s37, s21
  s_mov_b32 s38, 13824
  s_mov_b32 s39, 0x20000
  v_and_b32 v3, 3, v0
  v_lshrrev_b32 v4, 2, v0
  s_movk_i32 s26, 6912
  v_mul_lo_u32 v5, v4, s26
  v_lshl_add_u32 v5, v3, 3, v5
  v_lshlrev_b32 v6, 1, v4
  s_lshl_b32 s26, s25, 1
  buffer_load_ushort v10, v6, s[32:35], 0 offen offset:0
  buffer_load_ushort v11, v6, s[32:35], 0 offen offset:128
  buffer_load_ushort v12, v6, s[32:35], 0 offen offset:256
  buffer_load_ushort v13, v6, s[32:35], 0 offen offset:384
  buffer_load_ushort v14, v6, s[32:35], 0 offen offset:512
  buffer_load_ushort v15, v6, s[32:35], 0 offen offset:640
  buffer_load_ushort v16, v6, s[32:35], 0 offen offset:768
  buffer_load_ushort v17, v6, s[32:35], 0 offen offset:896
  buffer_load_ushort v18, v6, s[32:35], 0 offen offset:1024
  buffer_load_dwordx2 v[20:21], v5, s[28:31], s26 offen
  s_add_u32 s26, s26, 442368
  buffer_load_dwordx2 v[22:23], v5, s[28:31], s26 offen
  s_add_u32 s26, s26, 442368
  buffer_load_dwordx2 v[24:25], v5, s[28:31], s26 offen
  s_add_u32 s26, s26, 442368
  buffer_load_dwordx2 v[26:27], v5, s[28:31], s26 offen
  s_add_u32 s26, s26, 442368
  buffer_load_dwordx2 v[28:29], v5, s[28:31], s26 offen
  s_add_u32 s26, s26, 442368
  buffer_load_dwordx2 v[30:31], v5, s[28:31], s26 offen
  s_add_u32 s26, s26, 442368
  buffer_load_dwordx2 v[32:33], v5, s[28:31], s26 offen
  s_add_u32 s26, s26, 442368
  buffer_load_dwordx2 v[34:35], v5, s[28:31], s26 offen
  s_add_u32 s26, s26, 442368
  buffer_load_dwordx2 v[36:37], v5, s[28:31], s26 offen
  v_mov_b32 v40, 0
  v_mov_b32 v41, 0
  v_mov_b32 v42, 0
  v_mov_b32 v43, 0
  s_mov_b32 s27, 0xbfb8aa3b
  s_waitcnt vmcnt(9)
  v_lshlrev_b32 v10, 16, v10
  v_mul_f32 v44, s27, v10
  v_exp_f32 v44, v44
  s_nop 0
  v_add_f32 v44, 1.0, v44
  v_rcp_f32 v44, v44
  s_nop 0
  v_mul_f32 v10, v10, v44
  v_cvt_pk_bf16_f32 v10, v10, v10
  v_lshlrev_b32 v10, 16, v10
  v_lshlrev_b32 v11, 16, v11
  v_mul_f32 v44, s27, v11
  v_exp_f32 v44, v44
  s_nop 0
  v_add_f32 v44, 1.0, v44
  v_rcp_f32 v44, v44
  s_nop 0
  v_mul_f32 v11, v11, v44
  v_cvt_pk_bf16_f32 v11, v11, v11
  v_lshlrev_b32 v11, 16, v11
  v_lshlrev_b32 v12, 16, v12
  v_mul_f32 v44, s27, v12
  v_exp_f32 v44, v44
  s_nop 0
  v_add_f32 v44, 1.0, v44
  v_rcp_f32 v44, v44
  s_nop 0
  v_mul_f32 v12, v12, v44
  v_cvt_pk_bf16_f32 v12, v12, v12
  v_lshlrev_b32 v12, 16, v12
  v_lshlrev_b32 v13, 16, v13
  v_mul_f32 v44, s27, v13
  v_exp_f32 v44, v44
  s_nop 0
  v_add_f32 v44, 1.0, v44
  v_rcp_f32 v44, v44
  s_nop 0
  v_mul_f32 v13, v13, v44
  v_cvt_pk_bf16_f32 v13, v13, v13
  v_lshlrev_b32 v13, 16, v13
  v_lshlrev_b32 v14, 16, v14
  v_mul_f32 v44, s27, v14
  v_exp_f32 v44, v44
  s_nop 0
  v_add_f32 v44, 1.0, v44
  v_rcp_f32 v44, v44
  s_nop 0
  v_mul_f32 v14, v14, v44
  v_cvt_pk_bf16_f32 v14, v14, v14
  v_lshlrev_b32 v14, 16, v14
  v_lshlrev_b32 v15, 16, v15
  v_mul_f32 v44, s27, v15
  v_exp_f32 v44, v44
  s_nop 0
  v_add_f32 v44, 1.0, v44
  v_rcp_f32 v44, v44
  s_nop 0
  v_mul_f32 v15, v15, v44
  v_cvt_pk_bf16_f32 v15, v15, v15
  v_lshlrev_b32 v15, 16, v15
  v_lshlrev_b32 v16, 16, v16
  v_mul_f32 v44, s27, v16
  v_exp_f32 v44, v44
  s_nop 0
  v_add_f32 v44, 1.0, v44
  v_rcp_f32 v44, v44
  s_nop 0
  v_mul_f32 v16, v16, v44
  v_cvt_pk_bf16_f32 v16, v16, v16
  v_lshlrev_b32 v16, 16, v16
  v_lshlrev_b32 v17, 16, v17
  v_mul_f32 v44, s27, v17
  v_exp_f32 v44, v44
  s_nop 0
  v_add_f32 v44, 1.0, v44
  v_rcp_f32 v44, v44
  s_nop 0
  v_mul_f32 v17, v17, v44
  v_cvt_pk_bf16_f32 v17, v17, v17
  v_lshlrev_b32 v17, 16, v17
  v_lshlrev_b32 v18, 16, v18
  v_mul_f32 v44, s27, v18
  v_exp_f32 v44, v44
  s_nop 0
  v_add_f32 v44, 1.0, v44
  v_rcp_f32 v44, v44
  s_nop 0
  v_mul_f32 v18, v18, v44
  v_cvt_pk_bf16_f32 v18, v18, v18
  v_lshlrev_b32 v18, 16, v18
  s_waitcnt vmcnt(8)
  v_lshlrev_b32 v44, 16, v20
  v_and_b32 v45, 0xffff0000, v20
  v_fmac_f32 v40, v10, v44
  v_fmac_f32 v41, v10, v45
  v_lshlrev_b32 v44, 16, v21
  v_and_b32 v45, 0xffff0000, v21
  v_fmac_f32 v42, v10, v44
  v_fmac_f32 v43, v10, v45
  s_waitcnt vmcnt(7)
  v_lshlrev_b32 v44, 16, v22
  v_and_b32 v45, 0xffff0000, v22
  v_fmac_f32 v40, v11, v44
  v_fmac_f32 v41, v11, v45
  v_lshlrev_b32 v44, 16, v23
  v_and_b32 v45, 0xffff0000, v23
  v_fmac_f32 v42, v11, v44
  v_fmac_f32 v43, v11, v45
  s_waitcnt vmcnt(6)
  v_lshlrev_b32 v44, 16, v24
  v_and_b32 v45, 0xffff0000, v24
  v_fmac_f32 v40, v12, v44
  v_fmac_f32 v41, v12, v45
  v_lshlrev_b32 v44, 16, v25
  v_and_b32 v45, 0xffff0000, v25
  v_fmac_f32 v42, v12, v44
  v_fmac_f32 v43, v12, v45
  s_waitcnt vmcnt(5)
  v_lshlrev_b32 v44, 16, v26
  v_and_b32 v45, 0xffff0000, v26
  v_fmac_f32 v40, v13, v44
  v_fmac_f32 v41, v13, v45
  v_lshlrev_b32 v44, 16, v27
  v_and_b32 v45, 0xffff0000, v27
  v_fmac_f32 v42, v13, v44
  v_fmac_f32 v43, v13, v45
  s_waitcnt vmcnt(4)
  v_lshlrev_b32 v44, 16, v28
  v_and_b32 v45, 0xffff0000, v28
  v_fmac_f32 v40, v14, v44
  v_fmac_f32 v41, v14, v45
  v_lshlrev_b32 v44, 16, v29
  v_and_b32 v45, 0xffff0000, v29
  v_fmac_f32 v42, v14, v44
  v_fmac_f32 v43, v14, v45
  s_waitcnt vmcnt(3)
  v_lshlrev_b32 v44, 16, v30
  v_and_b32 v45, 0xffff0000, v30
  v_fmac_f32 v40, v15, v44
  v_fmac_f32 v41, v15, v45
  v_lshlrev_b32 v44, 16, v31
  v_and_b32 v45, 0xffff0000, v31
  v_fmac_f32 v42, v15, v44
  v_fmac_f32 v43, v15, v45
  s_waitcnt vmcnt(2)
  v_lshlrev_b32 v44, 16, v32
  v_and_b32 v45, 0xffff0000, v32
  v_fmac_f32 v40, v16, v44
  v_fmac_f32 v41, v16, v45
  v_lshlrev_b32 v44, 16, v33
  v_and_b32 v45, 0xffff0000, v33
  v_fmac_f32 v42, v16, v44
  v_fmac_f32 v43, v16, v45
  s_waitcnt vmcnt(1)
  v_lshlrev_b32 v44, 16, v34
  v_and_b32 v45, 0xffff0000, v34
  v_fmac_f32 v40, v17, v44
  v_fmac_f32 v41, v17, v45
  v_lshlrev_b32 v44, 16, v35
  v_and_b32 v45, 0xffff0000, v35
  v_fmac_f32 v42, v17, v44
  v_fmac_f32 v43, v17, v45
  s_waitcnt vmcnt(0)
  v_lshlrev_b32 v44, 16, v36
  v_and_b32 v45, 0xffff0000, v36
  v_fmac_f32 v40, v18, v44
  v_fmac_f32 v41, v18, v45
  v_lshlrev_b32 v44, 16, v37
  v_and_b32 v45, 0xffff0000, v37
  v_fmac_f32 v42, v18, v44
  v_fmac_f32 v43, v18, v45
  s_nop 1
  v_add_f32_dpp v40, v40, v40 row_ror:4 row_mask:0xf bank_mask:0xf
  v_add_f32_dpp v41, v41, v41 row_ror:4 row_mask:0xf bank_mask:0xf
  v_add_f32_dpp v42, v42, v42 row_ror:4 row_mask:0xf bank_mask:0xf
  v_add_f32_dpp v43, v43, v43 row_ror:4 row_mask:0xf bank_mask:0xf
  s_nop 1
  v_add_f32_dpp v40, v40, v40 row_ror:8 row_mask:0xf bank_mask:0xf
  v_add_f32_dpp v41, v41, v41 row_ror:8 row_mask:0xf bank_mask:0xf
  v_add_f32_dpp v42, v42, v42 row_ror:8 row_mask:0xf bank_mask:0xf
  v_add_f32_dpp v43, v43, v43 row_ror:8 row_mask:0xf bank_mask:0xf
  s_nop 1
  v_lshrrev_b32 v7, 4, v0
  v_lshlrev_b32 v7, 6, v7
  v_lshl_add_u32 v7, v3, 4, v7
  v_and_b32 v8, 15, v0
  v_cmp_gt_u32 vcc, 4, v8
  s_and_saveexec_b64 s[40:41], vcc
  ds_write_b128 v7, v[40:43]
  s_mov_b64 exec, s[40:41]
  s_waitcnt lgkmcnt(0)
  s_barrier
  s_cmp_lg_u32 s3, 0
  s_cbranch_scc1 L_k1_end
  v_cmp_gt_u32 vcc, 16, v0
  s_and_saveexec_b64 s[40:41], vcc
  v_lshlrev_b32 v7, 2, v0
  ds_read_b32 v50, v7 offset:0
  ds_read_b32 v51, v7 offset:64
  ds_read_b32 v52, v7 offset:128
  ds_read_b32 v53, v7 offset:192
  ds_read_b32 v54, v7 offset:256
  ds_read_b32 v55, v7 offset:320
  ds_read_b32 v56, v7 offset:384
  ds_read_b32 v57, v7 offset:448
  ds_read_b32 v58, v7 offset:512
  ds_read_b32 v59, v7 offset:576
  ds_read_b32 v60, v7 offset:640
  ds_read_b32 v61, v7 offset:704
  ds_read_b32 v62, v7 offset:768
  ds_read_b32 v63, v7 offset:832
  ds_read_b32 v64, v7 offset:896
  ds_read_b32 v65, v7 offset:960
  s_waitcnt lgkmcnt(0)
  v_add_f32 v50, v50, v58
  v_add_f32 v51, v51, v59
  v_add_f32 v52, v52, v60
  v_add_f32 v53, v53, v61
  v_add_f32 v54, v54, v62
  v_add_f32 v55, v55, v63
  v_add_f32 v56, v56, v64
  v_add_f32 v57, v57, v65
  v_add_f32 v50, v50, v54
  v_add_f32 v51, v51, v55
  v_add_f32 v52, v52, v56
  v_add_f32 v53, v53, v57
  v_add_f32 v50, v50, v52
  v_add_f32 v51, v51, v53
  v_add_f32 v50, v50, v51
  v_cvt_pk_bf16_f32 v50, v50, v50
  v_lshlrev_b32 v50, 16, v50
  s_mul_i32 s26, s24, 1821
  s_lshr_b32 s26, s26, 16
  s_cmp_eq_u32 s26, 1
  s_cselect_b32 s27, 1, 0
  s_cmp_eq_u32 s26, 4
  s_cselect_b32 s27, 1, s27
  s_cmp_eq_u32 s27, 0
  s_cbranch_scc1 L_k1_g_store
  v_add_f32 v50, 1.0, v50
  v_cvt_pk_bf16_f32 v50, v50, v50
  v_lshlrev_b32 v50, 16, v50
L_k1_g_store:
  s_lshl_b32 s27, s25, 2
  buffer_store_dword v50, v7, s[36:39], s27 offen
  s_sub_u32 s26, s26, 3
  s_cmp_ge_u32 s26, 2
  s_cbranch_scc1 L_k1_end
  s_add_u32 s40, s20, 16384
  s_addc_u32 s41, s21, 0
  s_mov_b32 s42, 2304
  s_mov_b32 s43, 0x20000
  s_sub_u32 s27, s25, 1728
  s_mul_i32 s28, s26, 1152
  s_sub_u32 s27, s27, s28
  s_add_u32 s27, s27, 576
  s_lshl_b32 s27, s27, 1
  v_lshrrev_b32 v51, 16, v50
  v_lshlrev_b32 v7, 1, v0
  buffer_store_short v51, v7, s[40:43], s27 offen
  s_branch L_k1_end
L_k1_pack:
  s_sub_u32 s22, s2, 224
  s_lshl_b32 s22, s22, 2
  s_add_u32 s22, s22, s3
  v_and_b32 v3, 15, v1
  v_lshrrev_b32 v4, 4, v1
  v_mov_b32 v10, 0
  v_mov_b32 v11, 0
  v_mov_b32 v12, 0
  v_mov_b32 v13, 0
  s_cmp_ge_u32 s22, 720
  s_cbranch_scc1 L_k1_pack_o
  s_add_u32 s36, s20, 36864
  s_addc_u32 s37, s21, 0
  s_mov_b32 s38, 737280
  s_mov_b32 s39, 0x20000
  s_mov_b32 s28, s6
  s_mov_b32 s29, s7
  s_mov_b32 s30, 663552
  s_mov_b32 s31, 0x20000
  s_mul_i32 s23, s22, 3641
  s_lshr_b32 s23, s23, 16
  s_mul_i32 s24, s23, 18
  s_sub_u32 s24, s22, s24
  s_cmp_ge_u32 s23, 36
  s_cbranch_scc1 L_k1_pack_kv
  s_branch L_k1_pack_big
L_k1_pack_o:
  s_sub_u32 s22, s22, 720
  s_add_u32 s36, s20, 774144
  s_addc_u32 s37, s21, 0
  s_mov_b32 s38, 663552
  s_mov_b32 s39, 0x20000
  s_mov_b32 s28, s12
  s_mov_b32 s29, s13
  s_mov_b32 s30, 663552
  s_mov_b32 s31, 0x20000
  s_mul_i32 s23, s22, 3641
  s_lshr_b32 s23, s23, 16
  s_mul_i32 s24, s23, 18
  s_sub_u32 s24, s22, s24
L_k1_pack_big:
  v_lshlrev_b32 v5, 3, v4
  s_lshl_b32 s25, s24, 5
  v_add_u32 v5, s25, v5
  s_movk_i32 s26, 1152
  v_mul_lo_u32 v5, v5, s26
  v_lshl_add_u32 v5, v3, 1, v5
  s_lshl_b32 s25, s23, 5
  s_add_u32 s26, s25, 4608
  buffer_load_ushort v20, v5, s[28:31], s25 offen offset:0
  buffer_load_ushort v21, v5, s[28:31], s25 offen offset:1152
  buffer_load_ushort v22, v5, s[28:31], s25 offen offset:2304
  buffer_load_ushort v23, v5, s[28:31], s25 offen offset:3456
  buffer_load_ushort v24, v5, s[28:31], s26 offen offset:0
  buffer_load_ushort v25, v5, s[28:31], s26 offen offset:1152
  buffer_load_ushort v26, v5, s[28:31], s26 offen offset:2304
  buffer_load_ushort v27, v5, s[28:31], s26 offen offset:3456
  s_branch L_k1_pack_st
L_k1_pack_kv:
  s_cmp_ge_u32 s23, 38
  s_cselect_b32 s28, s10, s8
  s_cselect_b32 s29, s11, s9
  s_mov_b32 s30, 20736
  s_and_b32 s25, s23, 1
  s_lshl_b32 s25, s25, 4
  v_add_u32 v6, s25, v3
  v_lshlrev_b32 v5, 3, v4
  s_lshl_b32 s25, s24, 5
  v_add_u32 v5, s25, v5
  v_mul_u32_u24 v5, 36, v5
  v_lshl_add_u32 v5, v6, 1, v5
  v_cmp_gt_u32 vcc, 18, v6
  v_mov_b32 v7, 0x40000000
  s_nop 0
  v_cndmask_b32 v5, v7, v5, vcc
  buffer_load_ushort v20, v5, s[28:31], 0 offen offset:0
  buffer_load_ushort v21, v5, s[28:31], 0 offen offset:36
  buffer_load_ushort v22, v5, s[28:31], 0 offen offset:72
  buffer_load_ushort v23, v5, s[28:31], 0 offen offset:108
  buffer_load_ushort v24, v5, s[28:31], 0 offen offset:144
  buffer_load_ushort v25, v5, s[28:31], 0 offen offset:180
  buffer_load_ushort v26, v5, s[28:31], 0 offen offset:216
  buffer_load_ushort v27, v5, s[28:31], 0 offen offset:252
L_k1_pack_st:
  v_lshlrev_b32 v6, 4, v1
  s_lshl_b32 s25, s22, 10
  s_waitcnt vmcnt(0)
  v_lshl_or_b32 v10, v21, 16, v20
  v_lshl_or_b32 v11, v23, 16, v22
  v_lshl_or_b32 v12, v25, 16, v24
  v_lshl_or_b32 v13, v27, 16, v26
  buffer_store_dwordx4 v[10:13], v6, s[36:39], s25 offen
  s_branch L_k1_end
L_k1_warm:
  s_sub_u32 s22, s2, 630
  s_lshl_b32 s22, s22, 2
  s_add_u32 s22, s22, s3
  s_cmp_ge_u32 s22, 648
  s_cselect_b32 s28, s46, s44
  s_cselect_b32 s29, s47, s45
  s_cselect_b32 s23, 648, 0
  s_mov_b32 s30, 5308416
  s_mov_b32 s31, 0x20000
  s_sub_u32 s22, s22, s23
  s_lshl_b32 s22, s22, 13
  v_lshlrev_b32 v5, 4, v1
  buffer_load_dwordx4 v[8:11], v5, s[28:31], s22 offen offset:0
  buffer_load_dwordx4 v[12:15], v5, s[28:31], s22 offen offset:1024
  buffer_load_dwordx4 v[16:19], v5, s[28:31], s22 offen offset:2048
  buffer_load_dwordx4 v[20:23], v5, s[28:31], s22 offen offset:3072
  s_add_u32 s22, s22, 4096
  buffer_load_dwordx4 v[24:27], v5, s[28:31], s22 offen offset:0
  buffer_load_dwordx4 v[28:31], v5, s[28:31], s22 offen offset:1024
  buffer_load_dwordx4 v[32:35], v5, s[28:31], s22 offen offset:2048
  buffer_load_dwordx4 v[36:39], v5, s[28:31], s22 offen offset:3072
  s_waitcnt vmcnt(0)
  s_branch L_k1_end
L_k1_ln:
  s_mov_b32 s22, s2
  s_mul_i32 s23, s22, 36864
  v_and_b32 v3, 7, v0
  v_lshrrev_b32 v4, 3, v0
  v_mul_u32_u24 v5, 1152, v4
  v_lshl_add_u32 v5, v3, 4, v5
  s_mov_b32 s28, s4
  s_mov_b32 s29, s5
  s_mov_b32 s30, 2359296
  s_mov_b32 s31, 0x20000
  s_add_u32 s36, s20, 20480
  s_addc_u32 s37, s21, 0
  s_mov_b32 s38, 16384
  s_mov_b32 s39, 0x20000
  buffer_load_dwordx4 v[12:15], v5, s[28:31], s23 offen offset:0
  buffer_load_dwordx4 v[16:19], v5, s[28:31], s23 offen offset:128
  buffer_load_dwordx4 v[20:23], v5, s[28:31], s23 offen offset:256
  buffer_load_dwordx4 v[24:27], v5, s[28:31], s23 offen offset:384
  buffer_load_dwordx4 v[28:31], v5, s[28:31], s23 offen offset:512
  buffer_load_dwordx4 v[32:35], v5, s[28:31], s23 offen offset:640
  buffer_load_dwordx4 v[36:39], v5, s[28:31], s23 offen offset:768
  buffer_load_dwordx4 v[40:43], v5, s[28:31], s23 offen offset:896
  buffer_load_dwordx4 v[44:47], v5, s[28:31], s23 offen offset:1024
  v_mov_b32 v60, 0x3f803f80
  v_mov_b32 v50, 0
  v_mov_b32 v51, 0
  v_mov_b32 v52, 0
  v_mov_b32 v53, 0
  s_waitcnt vmcnt(8)
  v_dot2c_f32_bf16 v50, v12, v60
  v_dot2c_f32_bf16 v52, v12, v12
  v_dot2c_f32_bf16 v51, v13, v60
  v_dot2c_f32_bf16 v53, v13, v13
  v_dot2c_f32_bf16 v50, v14, v60
  v_dot2c_f32_bf16 v52, v14, v14
  v_dot2c_f32_bf16 v51, v15, v60
  v_dot2c_f32_bf16 v53, v15, v15
  s_waitcnt vmcnt(7)
  v_dot2c_f32_bf16 v50, v16, v60
  v_dot2c_f32_bf16 v52, v16, v16
  v_dot2c_f32_bf16 v51, v17, v60
  v_dot2c_f32_bf16 v53, v17, v17
  v_dot2c_f32_bf16 v50, v18, v60
  v_dot2c_f32_bf16 v52, v18, v18
  v_dot2c_f32_bf16 v51, v19, v60
  v_dot2c_f32_bf16 v53, v19, v19
  s_waitcnt vmcnt(6)
  v_dot2c_f32_bf16 v50, v20, v60
  v_dot2c_f32_bf16 v52, v20, v20
  v_dot2c_f32_bf16 v51, v21, v60
  v_dot2c_f32_bf16 v53, v21, v21
  v_dot2c_f32_bf16 v50, v22, v60
  v_dot2c_f32_bf16 v52, v22, v22
  v_dot2c_f32_bf16 v51, v23, v60
  v_dot2c_f32_bf16 v53, v23, v23
  s_waitcnt vmcnt(5)
  v_dot2c_f32_bf16 v50, v24, v60
  v_dot2c_f32_bf16 v52, v24, v24
  v_dot2c_f32_bf16 v51, v25, v60
  v_dot2c_f32_bf16 v53, v25, v25
  v_dot2c_f32_bf16 v50, v26, v60
  v_dot2c_f32_bf16 v52, v26, v26
  v_dot2c_f32_bf16 v51, v27, v60
  v_dot2c_f32_bf16 v53, v27, v27
  s_waitcnt vmcnt(4)
  v_dot2c_f32_bf16 v50, v28, v60
  v_dot2c_f32_bf16 v52, v28, v28
  v_dot2c_f32_bf16 v51, v29, v60
  v_dot2c_f32_bf16 v53, v29, v29
  v_dot2c_f32_bf16 v50, v30, v60
  v_dot2c_f32_bf16 v52, v30, v30
  v_dot2c_f32_bf16 v51, v31, v60
  v_dot2c_f32_bf16 v53, v31, v31
  s_waitcnt vmcnt(3)
  v_dot2c_f32_bf16 v50, v32, v60
  v_dot2c_f32_bf16 v52, v32, v32
  v_dot2c_f32_bf16 v51, v33, v60
  v_dot2c_f32_bf16 v53, v33, v33
  v_dot2c_f32_bf16 v50, v34, v60
  v_dot2c_f32_bf16 v52, v34, v34
  v_dot2c_f32_bf16 v51, v35, v60
  v_dot2c_f32_bf16 v53, v35, v35
  s_waitcnt vmcnt(2)
  v_dot2c_f32_bf16 v50, v36, v60
  v_dot2c_f32_bf16 v52, v36, v36
  v_dot2c_f32_bf16 v51, v37, v60
  v_dot2c_f32_bf16 v53, v37, v37
  v_dot2c_f32_bf16 v50, v38, v60
  v_dot2c_f32_bf16 v52, v38, v38
  v_dot2c_f32_bf16 v51, v39, v60
  v_dot2c_f32_bf16 v53, v39, v39
  s_waitcnt vmcnt(1)
  v_dot2c_f32_bf16 v50, v40, v60
  v_dot2c_f32_bf16 v52, v40, v40
  v_dot2c_f32_bf16 v51, v41, v60
  v_dot2c_f32_bf16 v53, v41, v41
  v_dot2c_f32_bf16 v50, v42, v60
  v_dot2c_f32_bf16 v52, v42, v42
  v_dot2c_f32_bf16 v51, v43, v60
  v_dot2c_f32_bf16 v53, v43, v43
  s_waitcnt vmcnt(0)
  v_dot2c_f32_bf16 v50, v44, v60
  v_dot2c_f32_bf16 v52, v44, v44
  v_dot2c_f32_bf16 v51, v45, v60
  v_dot2c_f32_bf16 v53, v45, v45
  v_dot2c_f32_bf16 v50, v46, v60
  v_dot2c_f32_bf16 v52, v46, v46
  v_dot2c_f32_bf16 v51, v47, v60
  v_dot2c_f32_bf16 v53, v47, v47
  s_nop 2
  v_add_f32 v6, v50, v51
  v_add_f32 v8, v52, v53
  s_nop 1
  v_add_f32_dpp v6, v6, v6 quad_perm:[1,0,3,2] row_mask:0xf bank_mask:0xf
  s_nop 1
  v_add_f32_dpp v6, v6, v6 quad_perm:[2,3,0,1] row_mask:0xf bank_mask:0xf
  s_nop 1
  v_add_f32_dpp v6, v6, v6 row_half_mirror row_mask:0xf bank_mask:0xf
  s_nop 1
  v_add_f32_dpp v8, v8, v8 quad_perm:[1,0,3,2] row_mask:0xf bank_mask:0xf
  s_nop 1
  v_add_f32_dpp v8, v8, v8 quad_perm:[2,3,0,1] row_mask:0xf bank_mask:0xf
  s_nop 1
  v_add_f32_dpp v8, v8, v8 row_half_mirror row_mask:0xf bank_mask:0xf
  v_mul_f32 v6, 0x3ae38e39, v6
  v_mul_f32 v8, 0x3ae38e39, v8
  v_fma_f32 v8, -v6, v6, v8
  v_max_f32 v8, 0, v8
  v_cvt_pk_bf16_f32 v8, v8, v8
  v_lshlrev_b32 v8, 16, v8
  v_add_f32 v8, 0x3727c5ac, v8
  v_cvt_pk_bf16_f32 v8, v8, v8
  v_lshlrev_b32 v8, 16, v8
  v_sqrt_f32 v8, v8
  s_nop 0
  v_cvt_pk_bf16_f32 v8, v8, v8
  v_lshlrev_b32 v8, 16, v8
  v_rcp_f32 v8, v8
  v_cvt_pk_bf16_f32 v6, v6, v6
  v_lshlrev_b32 v6, 16, v6
  v_mul_f32 v9, v6, v8
  v_sub_f32 v9, 0, v9
  v_lshlrev_b32 v7, 3, v4
  s_lshl_b32 s23, s22, 8
  v_cmp_eq_u32 vcc, 0, v3
  s_and_saveexec_b64 s[40:41], vcc
  buffer_store_dwordx2 v[8:9], v7, s[36:39], s23 offen
L_k1_end:
  s_endpgm
.globl qkv_kernel
.p2align 8
.type qkv_kernel,@function
qkv_kernel:
  s_load_dwordx2 s[4:5], s[0:1], 0
  s_load_dwordx4 s[8:11], s[0:1], 48
  s_load_dwordx2 s[20:21], s[0:1], 104
  v_and_b32 v1, 63, v0
  v_lshrrev_b32 v2, 6, v0
  s_nop 0
  v_readfirstlane_b32 s3, v2
  s_cmp_ge_u32 s2, 256
  s_cbranch_scc1 L_k2_end
  s_movk_i32 s22, 911
  v_mul_lo_u32 v2, v0, s22
  v_lshrrev_b32 v2, 16, v2
  v_mul_u32_u24 v3, 72, v2
  v_sub_u32 v3, v0, v3
  s_and_b32 s22, s2, 7
  s_lshl_b32 s22, s22, 2
  s_lshr_b32 s23, s2, 3
  s_and_b32 s23, s23, 3
  s_add_u32 s22, s22, s23
  s_lshr_b32 s23, s2, 5
  s_mul_i32 s23, s23, 5
  s_add_u32 s23, s23, s3
  v_mul_u32_u24 v4, 1152, v2
  v_lshl_add_u32 v4, v3, 4, v4
  s_mul_i32 s40, s22, 73728
  v_lshlrev_b32 v5, 3, v2
  s_lshl_b32 s41, s22, 9
  v_lshlrev_b32 v6, 5, v3
  s_waitcnt lgkmcnt(0)
  s_mov_b32 s24, s4
  s_mov_b32 s25, s5
  s_mov_b32 s26, 2359296
  s_mov_b32 s27, 0x20000
  s_add_u32 s28, s20, 20480
  s_addc_u32 s29, s21, 0
  s_mov_b32 s30, 16384
  s_mov_b32 s31, 0x20000
  s_mov_b32 s32, s20
  s_mov_b32 s33, s21
  s_mov_b32 s34, 13824
  s_mov_b32 s35, 0x20000
  s_add_u32 s36, s20, 36864
  s_addc_u32 s37, s21, 0
  s_mov_b32 s38, 737280
  s_mov_b32 s39, 0x20000
  v_lshlrev_b32 v7, 4, v1
  s_cmp_ge_u32 s3, 6
  s_cbranch_scc1 L_k2_x
  s_lshl_b32 s42, s3, 10
  s_cmp_eq_u32 s3, 5
  s_cselect_b32 s44, s28, s32
  s_cselect_b32 s45, s29, s33
  s_cselect_b32 s46, s30, s34
  s_mov_b32 s47, 0x20000
  s_cselect_b32 s43, s41, s42
  s_add_u32 m0, s42, 73728
  s_nop 0
  buffer_load_dwordx4 v7, s[44:47], s43 offen lds
L_k2_x:
  buffer_load_dwordx4 v[80:83], v4, s[24:27], s40 offen
  s_add_u32 s40, s40, 9216
  buffer_load_dwordx4 v[84:87], v4, s[24:27], s40 offen
  s_add_u32 s40, s40, 9216
  buffer_load_dwordx4 v[88:91], v4, s[24:27], s40 offen
  s_add_u32 s40, s40, 9216
  buffer_load_dwordx4 v[92:95], v4, s[24:27], s40 offen
  s_add_u32 s40, s40, 9216
  buffer_load_dwordx4 v[96:99], v4, s[24:27], s40 offen
  s_add_u32 s40, s40, 9216
  buffer_load_dwordx4 v[100:103], v4, s[24:27], s40 offen
  s_add_u32 s40, s40, 9216
  buffer_load_dwordx4 v[104:107], v4, s[24:27], s40 offen
  s_add_u32 s40, s40, 9216
  buffer_load_dwordx4 v[108:111], v4, s[24:27], s40 offen
  s_mul_i32 s40, s23, 18432
  v_add_u32 v5, 78848, v5
  v_add_u32 v6, 73728, v6
  s_waitcnt vmcnt(8)
  s_barrier
  ds_read_b128 v[128:131], v6
  ds_read_b128 v[132:135], v6 offset:16
  ds_read_b128 v[136:139], v6 offset:2304
  ds_read_b128 v[140:143], v6 offset:2320
  ds_read_b64 v[112:113], v5 offset:0
  ds_read_b64 v[114:115], v5 offset:64
  ds_read_b64 v[116:117], v5 offset:128
  ds_read_b64 v[118:119], v5 offset:192
  ds_read_b64 v[120:121], v5 offset:256
  ds_read_b64 v[122:123], v5 offset:320
  ds_read_b64 v[124:125], v5 offset:384
  ds_read_b64 v[126:127], v5 offset:448
  v_xor_b32 v5, v3, v2
  v_mul_u32_u24 v4, 1152, v2
  v_lshl_add_u32 v4, v5, 4, v4
  s_cmp_ge_u32 s3, 5
  s_cbranch_scc1 L_k2_ln2
  s_waitcnt vmcnt(7) lgkmcnt(0)
  buffer_load_dwordx4 v[8:11], v7, s[36:39], s40 offen offset:0
  buffer_load_dwordx4 v[12:15], v7, s[36:39], s40 offen offset:1024
  buffer_load_dwordx4 v[16:19], v7, s[36:39], s40 offen offset:2048
  v_lshlrev_b32 v144, 16, v80
  v_and_b32 v145, 0xffff0000, v80
  v_fma_f32 v144, v144, v112, v113
  v_fma_f32 v145, v145, v112, v113
  v_fma_f32 v144, v144, v136, v128
  v_fma_f32 v145, v145, v137, v129
  v_cvt_pk_bf16_f32 v80, v144, v145
  v_lshlrev_b32 v144, 16, v81
  v_and_b32 v145, 0xffff0000, v81
  v_fma_f32 v144, v144, v112, v113
  v_fma_f32 v145, v145, v112, v113
  v_fma_f32 v144, v144, v138, v130
  v_fma_f32 v145, v145, v139, v131
  v_cvt_pk_bf16_f32 v81, v144, v145
  v_lshlrev_b32 v144, 16, v82
  v_and_b32 v145, 0xffff0000, v82
  v_fma_f32 v144, v144, v112, v113
  v_fma_f32 v145, v145, v112, v113
  v_fma_f32 v144, v144, v140, v132
  v_fma_f32 v145, v145, v141, v133
  v_cvt_pk_bf16_f32 v82, v144, v145
  v_lshlrev_b32 v144, 16, v83
  v_and_b32 v145, 0xffff0000, v83
  v_fma_f32 v144, v144, v112, v113
  v_fma_f32 v145, v145, v112, v113
  v_fma_f32 v144, v144, v142, v134
  v_fma_f32 v145, v145, v143, v135
  v_cvt_pk_bf16_f32 v83, v144, v145
  ds_write_b128 v4, v[80:83] offset:0
  s_waitcnt vmcnt(9)
  buffer_load_dwordx4 v[20:23], v7, s[36:39], s40 offen offset:3072
  s_add_u32 s40, s40, 4096
  buffer_load_dwordx4 v[24:27], v7, s[36:39], s40 offen offset:0
  buffer_load_dwordx4 v[28:31], v7, s[36:39], s40 offen offset:1024
  v_lshlrev_b32 v144, 16, v84
  v_and_b32 v145, 0xffff0000, v84
  v_fma_f32 v144, v144, v114, v115
  v_fma_f32 v145, v145, v114, v115
  v_fma_f32 v144, v144, v136, v128
  v_fma_f32 v145, v145, v137, v129
  v_cvt_pk_bf16_f32 v84, v144, v145
  v_lshlrev_b32 v144, 16, v85
  v_and_b32 v145, 0xffff0000, v85
  v_fma_f32 v144, v144, v114, v115
  v_fma_f32 v145, v145, v114, v115
  v_fma_f32 v144, v144, v138, v130
  v_fma_f32 v145, v145, v139, v131
  v_cvt_pk_bf16_f32 v85, v144, v145
  v_lshlrev_b32 v144, 16, v86
  v_and_b32 v145, 0xffff0000, v86
  v_fma_f32 v144, v144, v114, v115
  v_fma_f32 v145, v145, v114, v115
  v_fma_f32 v144, v144, v140, v132
  v_fma_f32 v145, v145, v141, v133
  v_cvt_pk_bf16_f32 v86, v144, v145
  v_lshlrev_b32 v144, 16, v87
  v_and_b32 v145, 0xffff0000, v87
  v_fma_f32 v144, v144, v114, v115
  v_fma_f32 v145, v145, v114, v115
  v_fma_f32 v144, v144, v142, v134
  v_fma_f32 v145, v145, v143, v135
  v_cvt_pk_bf16_f32 v87, v144, v145
  ds_write_b128 v4, v[84:87] offset:9216
  s_waitcnt vmcnt(11)
  buffer_load_dwordx4 v[32:35], v7, s[36:39], s40 offen offset:2048
  buffer_load_dwordx4 v[36:39], v7, s[36:39], s40 offen offset:3072
  s_add_u32 s40, s40, 4096
  buffer_load_dwordx4 v[40:43], v7, s[36:39], s40 offen offset:0
  v_lshlrev_b32 v144, 16, v88
  v_and_b32 v145, 0xffff0000, v88
  v_fma_f32 v144, v144, v116, v117
  v_fma_f32 v145, v145, v116, v117
  v_fma_f32 v144, v144, v136, v128
  v_fma_f32 v145, v145, v137, v129
  v_cvt_pk_bf16_f32 v88, v144, v145
  v_lshlrev_b32 v144, 16, v89
  v_and_b32 v145, 0xffff0000, v89
  v_fma_f32 v144, v144, v116, v117
  v_fma_f32 v145, v145, v116, v117
  v_fma_f32 v144, v144, v138, v130
  v_fma_f32 v145, v145, v139, v131
  v_cvt_pk_bf16_f32 v89, v144, v145
  v_lshlrev_b32 v144, 16, v90
  v_and_b32 v145, 0xffff0000, v90
  v_fma_f32 v144, v144, v116, v117
  v_fma_f32 v145, v145, v116, v117
  v_fma_f32 v144, v144, v140, v132
  v_fma_f32 v145, v145, v141, v133
  v_cvt_pk_bf16_f32 v90, v144, v145
  v_lshlrev_b32 v144, 16, v91
  v_and_b32 v145, 0xffff0000, v91
  v_fma_f32 v144, v144, v116, v117
  v_fma_f32 v145, v145, v116, v117
  v_fma_f32 v144, v144, v142, v134
  v_fma_f32 v145, v145, v143, v135
  v_cvt_pk_bf16_f32 v91, v144, v145
  ds_write_b128 v4, v[88:91] offset:18432
  s_waitcnt vmcnt(13)
  buffer_load_dwordx4 v[44:47], v7, s[36:39], s40 offen offset:1024
  buffer_load_dwordx4 v[48:51], v7, s[36:39], s40 offen offset:2048
  buffer_load_dwordx4 v[52:55], v7, s[36:39], s40 offen offset:3072
  s_add_u32 s40, s40, 4096
  v_lshlrev_b32 v144, 16, v92
  v_and_b32 v145, 0xffff0000, v92
  v_fma_f32 v144, v144, v118, v119
  v_fma_f32 v145, v145, v118, v119
  v_fma_f32 v144, v144, v136, v128
  v_fma_f32 v145, v145, v137, v129
  v_cvt_pk_bf16_f32 v92, v144, v145
  v_lshlrev_b32 v144, 16, v93
  v_and_b32 v145, 0xffff0000, v93
  v_fma_f32 v144, v144, v118, v119
  v_fma_f32 v145, v145, v118, v119
  v_fma_f32 v144, v144, v138, v130
  v_fma_f32 v145, v145, v139, v131
  v_cvt_pk_bf16_f32 v93, v144, v145
  v_lshlrev_b32 v144, 16, v94
  v_and_b32 v145, 0xffff0000, v94
  v_fma_f32 v144, v144, v118, v119
  v_fma_f32 v145, v145, v118, v119
  v_fma_f32 v144, v144, v140, v132
  v_fma_f32 v145, v145, v141, v133
  v_cvt_pk_bf16_f32 v94, v144, v145
  v_lshlrev_b32 v144, 16, v95
  v_and_b32 v145, 0xffff0000, v95
  v_fma_f32 v144, v144, v118, v119
  v_fma_f32 v145, v145, v118, v119
  v_fma_f32 v144, v144, v142, v134
  v_fma_f32 v145, v145, v143, v135
  v_cvt_pk_bf16_f32 v95, v144, v145
  ds_write_b128 v4, v[92:95] offset:27648
  s_waitcnt vmcnt(15)
  buffer_load_dwordx4 v[56:59], v7, s[36:39], s40 offen offset:0
  buffer_load_dwordx4 v[60:63], v7, s[36:39], s40 offen offset:1024
  buffer_load_dwordx4 v[64:67], v7, s[36:39], s40 offen offset:2048
  v_lshlrev_b32 v144, 16, v96
  v_and_b32 v145, 0xffff0000, v96
  v_fma_f32 v144, v144, v120, v121
  v_fma_f32 v145, v145, v120, v121
  v_fma_f32 v144, v144, v136, v128
  v_fma_f32 v145, v145, v137, v129
  v_cvt_pk_bf16_f32 v96, v144, v145
  v_lshlrev_b32 v144, 16, v97
  v_and_b32 v145, 0xffff0000, v97
  v_fma_f32 v144, v144, v120, v121
  v_fma_f32 v145, v145, v120, v121
  v_fma_f32 v144, v144, v138, v130
  v_fma_f32 v145, v145, v139, v131
  v_cvt_pk_bf16_f32 v97, v144, v145
  v_lshlrev_b32 v144, 16, v98
  v_and_b32 v145, 0xffff0000, v98
  v_fma_f32 v144, v144, v120, v121
  v_fma_f32 v145, v145, v120, v121
  v_fma_f32 v144, v144, v140, v132
  v_fma_f32 v145, v145, v141, v133
  v_cvt_pk_bf16_f32 v98, v144, v145
  v_lshlrev_b32 v144, 16, v99
  v_and_b32 v145, 0xffff0000, v99
  v_fma_f32 v144, v144, v120, v121
  v_fma_f32 v145, v145, v120, v121
  v_fma_f32 v144, v144, v142, v134
  v_fma_f32 v145, v145, v143, v135
  v_cvt_pk_bf16_f32 v99, v144, v145
  ds_write_b128 v4, v[96:99] offset:36864
  s_waitcnt vmcnt(17)
  buffer_load_dwordx4 v[68:71], v7, s[36:39], s40 offen offset:3072
  s_add_u32 s40, s40, 4096
  buffer_load_dwordx4 v[72:75], v7, s[36:39], s40 offen offset:0
  buffer_load_dwordx4 v[76:79], v7, s[36:39], s40 offen offset:1024
  v_lshlrev_b32 v144, 16, v100
  v_and_b32 v145, 0xffff0000, v100
  v_fma_f32 v144, v144, v122, v123
  v_fma_f32 v145, v145, v122, v123
  v_fma_f32 v144, v144, v136, v128
  v_fma_f32 v145, v145, v137, v129
  v_cvt_pk_bf16_f32 v100, v144, v145
  v_lshlrev_b32 v144, 16, v101
  v_and_b32 v145, 0xffff0000, v101
  v_fma_f32 v144, v144, v122, v123
  v_fma_f32 v145, v145, v122, v123
  v_fma_f32 v144, v144, v138, v130
  v_fma_f32 v145, v145, v139, v131
  v_cvt_pk_bf16_f32 v101, v144, v145
  v_lshlrev_b32 v144, 16, v102
  v_and_b32 v145, 0xffff0000, v102
  v_fma_f32 v144, v144, v122, v123
  v_fma_f32 v145, v145, v122, v123
  v_fma_f32 v144, v144, v140, v132
  v_fma_f32 v145, v145, v141, v133
  v_cvt_pk_bf16_f32 v102, v144, v145
  v_lshlrev_b32 v144, 16, v103
  v_and_b32 v145, 0xffff0000, v103
  v_fma_f32 v144, v144, v122, v123
  v_fma_f32 v145, v145, v122, v123
  v_fma_f32 v144, v144, v142, v134
  v_fma_f32 v145, v145, v143, v135
  v_cvt_pk_bf16_f32 v103, v144, v145
  ds_write_b128 v4, v[100:103] offset:46080
  s_waitcnt vmcnt(19)
  v_lshlrev_b32 v144, 16, v104
  v_and_b32 v145, 0xffff0000, v104
  v_fma_f32 v144, v144, v124, v125
  v_fma_f32 v145, v145, v124, v125
  v_fma_f32 v144, v144, v136, v128
  v_fma_f32 v145, v145, v137, v129
  v_cvt_pk_bf16_f32 v104, v144, v145
  v_lshlrev_b32 v144, 16, v105
  v_and_b32 v145, 0xffff0000, v105
  v_fma_f32 v144, v144, v124, v125
  v_fma_f32 v145, v145, v124, v125
  v_fma_f32 v144, v144, v138, v130
  v_fma_f32 v145, v145, v139, v131
  v_cvt_pk_bf16_f32 v105, v144, v145
  v_lshlrev_b32 v144, 16, v106
  v_and_b32 v145, 0xffff0000, v106
  v_fma_f32 v144, v144, v124, v125
  v_fma_f32 v145, v145, v124, v125
  v_fma_f32 v144, v144, v140, v132
  v_fma_f32 v145, v145, v141, v133
  v_cvt_pk_bf16_f32 v106, v144, v145
  v_lshlrev_b32 v144, 16, v107
  v_and_b32 v145, 0xffff0000, v107
  v_fma_f32 v144, v144, v124, v125
  v_fma_f32 v145, v145, v124, v125
  v_fma_f32 v144, v144, v142, v134
  v_fma_f32 v145, v145, v143, v135
  v_cvt_pk_bf16_f32 v107, v144, v145
  ds_write_b128 v4, v[104:107] offset:55296
  s_waitcnt vmcnt(18)
  v_lshlrev_b32 v144, 16, v108
  v_and_b32 v145, 0xffff0000, v108
  v_fma_f32 v144, v144, v126, v127
  v_fma_f32 v145, v145, v126, v127
  v_fma_f32 v144, v144, v136, v128
  v_fma_f32 v145, v145, v137, v129
  v_cvt_pk_bf16_f32 v108, v144, v145
  v_lshlrev_b32 v144, 16, v109
  v_and_b32 v145, 0xffff0000, v109
  v_fma_f32 v144, v144, v126, v127
  v_fma_f32 v145, v145, v126, v127
  v_fma_f32 v144, v144, v138, v130
  v_fma_f32 v145, v145, v139, v131
  v_cvt_pk_bf16_f32 v109, v144, v145
  v_lshlrev_b32 v144, 16, v110
  v_and_b32 v145, 0xffff0000, v110
  v_fma_f32 v144, v144, v126, v127
  v_fma_f32 v145, v145, v126, v127
  v_fma_f32 v144, v144, v140, v132
  v_fma_f32 v145, v145, v141, v133
  v_cvt_pk_bf16_f32 v110, v144, v145
  v_lshlrev_b32 v144, 16, v111
  v_and_b32 v145, 0xffff0000, v111
  v_fma_f32 v144, v144, v126, v127
  v_fma_f32 v145, v145, v126, v127
  v_fma_f32 v144, v144, v142, v134
  v_fma_f32 v145, v145, v143, v135
  v_cvt_pk_bf16_f32 v111, v144, v145
  ds_write_b128 v4, v[108:111] offset:64512
  s_branch L_k2_lnd
L_k2_ln2:
  s_waitcnt vmcnt(7) lgkmcnt(0)
  v_lshlrev_b32 v144, 16, v80
  v_and_b32 v145, 0xffff0000, v80
  v_fma_f32 v144, v144, v112, v113
  v_fma_f32 v145, v145, v112, v113
  v_fma_f32 v144, v144, v136, v128
  v_fma_f32 v145, v145, v137, v129
  v_cvt_pk_bf16_f32 v80, v144, v145
  v_lshlrev_b32 v144, 16, v81
  v_and_b32 v145, 0xffff0000, v81
  v_fma_f32 v144, v144, v112, v113
  v_fma_f32 v145, v145, v112, v113
  v_fma_f32 v144, v144, v138, v130
  v_fma_f32 v145, v145, v139, v131
  v_cvt_pk_bf16_f32 v81, v144, v145
  v_lshlrev_b32 v144, 16, v82
  v_and_b32 v145, 0xffff0000, v82
  v_fma_f32 v144, v144, v112, v113
  v_fma_f32 v145, v145, v112, v113
  v_fma_f32 v144, v144, v140, v132
  v_fma_f32 v145, v145, v141, v133
  v_cvt_pk_bf16_f32 v82, v144, v145
  v_lshlrev_b32 v144, 16, v83
  v_and_b32 v145, 0xffff0000, v83
  v_fma_f32 v144, v144, v112, v113
  v_fma_f32 v145, v145, v112, v113
  v_fma_f32 v144, v144, v142, v134
  v_fma_f32 v145, v145, v143, v135
  v_cvt_pk_bf16_f32 v83, v144, v145
  ds_write_b128 v4, v[80:83] offset:0
  s_waitcnt vmcnt(6)
  v_lshlrev_b32 v144, 16, v84
  v_and_b32 v145, 0xffff0000, v84
  v_fma_f32 v144, v144, v114, v115
  v_fma_f32 v145, v145, v114, v115
  v_fma_f32 v144, v144, v136, v128
  v_fma_f32 v145, v145, v137, v129
  v_cvt_pk_bf16_f32 v84, v144, v145
  v_lshlrev_b32 v144, 16, v85
  v_and_b32 v145, 0xffff0000, v85
  v_fma_f32 v144, v144, v114, v115
  v_fma_f32 v145, v145, v114, v115
  v_fma_f32 v144, v144, v138, v130
  v_fma_f32 v145, v145, v139, v131
  v_cvt_pk_bf16_f32 v85, v144, v145
  v_lshlrev_b32 v144, 16, v86
  v_and_b32 v145, 0xffff0000, v86
  v_fma_f32 v144, v144, v114, v115
  v_fma_f32 v145, v145, v114, v115
  v_fma_f32 v144, v144, v140, v132
  v_fma_f32 v145, v145, v141, v133
  v_cvt_pk_bf16_f32 v86, v144, v145
  v_lshlrev_b32 v144, 16, v87
  v_and_b32 v145, 0xffff0000, v87
  v_fma_f32 v144, v144, v114, v115
  v_fma_f32 v145, v145, v114, v115
  v_fma_f32 v144, v144, v142, v134
  v_fma_f32 v145, v145, v143, v135
  v_cvt_pk_bf16_f32 v87, v144, v145
  ds_write_b128 v4, v[84:87] offset:9216
  s_waitcnt vmcnt(5)
  v_lshlrev_b32 v144, 16, v88
  v_and_b32 v145, 0xffff0000, v88
  v_fma_f32 v144, v144, v116, v117
  v_fma_f32 v145, v145, v116, v117
  v_fma_f32 v144, v144, v136, v128
  v_fma_f32 v145, v145, v137, v129
  v_cvt_pk_bf16_f32 v88, v144, v145
  v_lshlrev_b32 v144, 16, v89
  v_and_b32 v145, 0xffff0000, v89
  v_fma_f32 v144, v144, v116, v117
  v_fma_f32 v145, v145, v116, v117
  v_fma_f32 v144, v144, v138, v130
  v_fma_f32 v145, v145, v139, v131
  v_cvt_pk_bf16_f32 v89, v144, v145
  v_lshlrev_b32 v144, 16, v90
  v_and_b32 v145, 0xffff0000, v90
  v_fma_f32 v144, v144, v116, v117
  v_fma_f32 v145, v145, v116, v117
  v_fma_f32 v144, v144, v140, v132
  v_fma_f32 v145, v145, v141, v133
  v_cvt_pk_bf16_f32 v90, v144, v145
  v_lshlrev_b32 v144, 16, v91
  v_and_b32 v145, 0xffff0000, v91
  v_fma_f32 v144, v144, v116, v117
  v_fma_f32 v145, v145, v116, v117
  v_fma_f32 v144, v144, v142, v134
  v_fma_f32 v145, v145, v143, v135
  v_cvt_pk_bf16_f32 v91, v144, v145
  ds_write_b128 v4, v[88:91] offset:18432
  s_waitcnt vmcnt(4)
  v_lshlrev_b32 v144, 16, v92
  v_and_b32 v145, 0xffff0000, v92
  v_fma_f32 v144, v144, v118, v119
  v_fma_f32 v145, v145, v118, v119
  v_fma_f32 v144, v144, v136, v128
  v_fma_f32 v145, v145, v137, v129
  v_cvt_pk_bf16_f32 v92, v144, v145
  v_lshlrev_b32 v144, 16, v93
  v_and_b32 v145, 0xffff0000, v93
  v_fma_f32 v144, v144, v118, v119
  v_fma_f32 v145, v145, v118, v119
  v_fma_f32 v144, v144, v138, v130
  v_fma_f32 v145, v145, v139, v131
  v_cvt_pk_bf16_f32 v93, v144, v145
  v_lshlrev_b32 v144, 16, v94
  v_and_b32 v145, 0xffff0000, v94
  v_fma_f32 v144, v144, v118, v119
  v_fma_f32 v145, v145, v118, v119
  v_fma_f32 v144, v144, v140, v132
  v_fma_f32 v145, v145, v141, v133
  v_cvt_pk_bf16_f32 v94, v144, v145
  v_lshlrev_b32 v144, 16, v95
  v_and_b32 v145, 0xffff0000, v95
  v_fma_f32 v144, v144, v118, v119
  v_fma_f32 v145, v145, v118, v119
  v_fma_f32 v144, v144, v142, v134
  v_fma_f32 v145, v145, v143, v135
  v_cvt_pk_bf16_f32 v95, v144, v145
  ds_write_b128 v4, v[92:95] offset:27648
  s_waitcnt vmcnt(3)
  v_lshlrev_b32 v144, 16, v96
  v_and_b32 v145, 0xffff0000, v96
  v_fma_f32 v144, v144, v120, v121
  v_fma_f32 v145, v145, v120, v121
  v_fma_f32 v144, v144, v136, v128
  v_fma_f32 v145, v145, v137, v129
  v_cvt_pk_bf16_f32 v96, v144, v145
  v_lshlrev_b32 v144, 16, v97
  v_and_b32 v145, 0xffff0000, v97
  v_fma_f32 v144, v144, v120, v121
  v_fma_f32 v145, v145, v120, v121
  v_fma_f32 v144, v144, v138, v130
  v_fma_f32 v145, v145, v139, v131
  v_cvt_pk_bf16_f32 v97, v144, v145
  v_lshlrev_b32 v144, 16, v98
  v_and_b32 v145, 0xffff0000, v98
  v_fma_f32 v144, v144, v120, v121
  v_fma_f32 v145, v145, v120, v121
  v_fma_f32 v144, v144, v140, v132
  v_fma_f32 v145, v145, v141, v133
  v_cvt_pk_bf16_f32 v98, v144, v145
  v_lshlrev_b32 v144, 16, v99
  v_and_b32 v145, 0xffff0000, v99
  v_fma_f32 v144, v144, v120, v121
  v_fma_f32 v145, v145, v120, v121
  v_fma_f32 v144, v144, v142, v134
  v_fma_f32 v145, v145, v143, v135
  v_cvt_pk_bf16_f32 v99, v144, v145
  ds_write_b128 v4, v[96:99] offset:36864
  s_waitcnt vmcnt(2)
  v_lshlrev_b32 v144, 16, v100
  v_and_b32 v145, 0xffff0000, v100
  v_fma_f32 v144, v144, v122, v123
  v_fma_f32 v145, v145, v122, v123
  v_fma_f32 v144, v144, v136, v128
  v_fma_f32 v145, v145, v137, v129
  v_cvt_pk_bf16_f32 v100, v144, v145
  v_lshlrev_b32 v144, 16, v101
  v_and_b32 v145, 0xffff0000, v101
  v_fma_f32 v144, v144, v122, v123
  v_fma_f32 v145, v145, v122, v123
  v_fma_f32 v144, v144, v138, v130
  v_fma_f32 v145, v145, v139, v131
  v_cvt_pk_bf16_f32 v101, v144, v145
  v_lshlrev_b32 v144, 16, v102
  v_and_b32 v145, 0xffff0000, v102
  v_fma_f32 v144, v144, v122, v123
  v_fma_f32 v145, v145, v122, v123
  v_fma_f32 v144, v144, v140, v132
  v_fma_f32 v145, v145, v141, v133
  v_cvt_pk_bf16_f32 v102, v144, v145
  v_lshlrev_b32 v144, 16, v103
  v_and_b32 v145, 0xffff0000, v103
  v_fma_f32 v144, v144, v122, v123
  v_fma_f32 v145, v145, v122, v123
  v_fma_f32 v144, v144, v142, v134
  v_fma_f32 v145, v145, v143, v135
  v_cvt_pk_bf16_f32 v103, v144, v145
  ds_write_b128 v4, v[100:103] offset:46080
  s_waitcnt vmcnt(1)
  v_lshlrev_b32 v144, 16, v104
  v_and_b32 v145, 0xffff0000, v104
  v_fma_f32 v144, v144, v124, v125
  v_fma_f32 v145, v145, v124, v125
  v_fma_f32 v144, v144, v136, v128
  v_fma_f32 v145, v145, v137, v129
  v_cvt_pk_bf16_f32 v104, v144, v145
  v_lshlrev_b32 v144, 16, v105
  v_and_b32 v145, 0xffff0000, v105
  v_fma_f32 v144, v144, v124, v125
  v_fma_f32 v145, v145, v124, v125
  v_fma_f32 v144, v144, v138, v130
  v_fma_f32 v145, v145, v139, v131
  v_cvt_pk_bf16_f32 v105, v144, v145
  v_lshlrev_b32 v144, 16, v106
  v_and_b32 v145, 0xffff0000, v106
  v_fma_f32 v144, v144, v124, v125
  v_fma_f32 v145, v145, v124, v125
  v_fma_f32 v144, v144, v140, v132
  v_fma_f32 v145, v145, v141, v133
  v_cvt_pk_bf16_f32 v106, v144, v145
  v_lshlrev_b32 v144, 16, v107
  v_and_b32 v145, 0xffff0000, v107
  v_fma_f32 v144, v144, v124, v125
  v_fma_f32 v145, v145, v124, v125
  v_fma_f32 v144, v144, v142, v134
  v_fma_f32 v145, v145, v143, v135
  v_cvt_pk_bf16_f32 v107, v144, v145
  ds_write_b128 v4, v[104:107] offset:55296
  s_waitcnt vmcnt(0)
  v_lshlrev_b32 v144, 16, v108
  v_and_b32 v145, 0xffff0000, v108
  v_fma_f32 v144, v144, v126, v127
  v_fma_f32 v145, v145, v126, v127
  v_fma_f32 v144, v144, v136, v128
  v_fma_f32 v145, v145, v137, v129
  v_cvt_pk_bf16_f32 v108, v144, v145
  v_lshlrev_b32 v144, 16, v109
  v_and_b32 v145, 0xffff0000, v109
  v_fma_f32 v144, v144, v126, v127
  v_fma_f32 v145, v145, v126, v127
  v_fma_f32 v144, v144, v138, v130
  v_fma_f32 v145, v145, v139, v131
  v_cvt_pk_bf16_f32 v109, v144, v145
  v_lshlrev_b32 v144, 16, v110
  v_and_b32 v145, 0xffff0000, v110
  v_fma_f32 v144, v144, v126, v127
  v_fma_f32 v145, v145, v126, v127
  v_fma_f32 v144, v144, v140, v132
  v_fma_f32 v145, v145, v141, v133
  v_cvt_pk_bf16_f32 v110, v144, v145
  v_lshlrev_b32 v144, 16, v111
  v_and_b32 v145, 0xffff0000, v111
  v_fma_f32 v144, v144, v126, v127
  v_fma_f32 v145, v145, v126, v127
  v_fma_f32 v144, v144, v142, v134
  v_fma_f32 v145, v145, v143, v135
  v_cvt_pk_bf16_f32 v111, v144, v145
  ds_write_b128 v4, v[108:111] offset:64512
L_k2_lnd:
  v_and_b32 v3, 15, v1
  v_lshrrev_b32 v4, 4, v1
  v_and_b32 v7, 7, v3
  v_xor_b32 v5, v4, v7
  v_xor_b32 v6, 4, v5
  v_mul_u32_u24 v7, 1152, v3
  v_lshl_add_u32 v5, v5, 4, v7
  v_lshl_add_u32 v6, v6, 4, v7
  s_waitcnt lgkmcnt(0)
  s_barrier
  s_cmp_ge_u32 s3, 5
  s_cbranch_scc1 L_k2_side
  s_cmp_ge_u32 s23, 38
  s_cbranch_scc1 L_k2_v
  ds_read_b128 v[80:83], v5 offset:0
  ds_read_b128 v[84:87], v5 offset:18432
  ds_read_b128 v[88:91], v5 offset:36864
  ds_read_b128 v[92:95], v5 offset:55296
  ds_read_b128 v[96:99], v6 offset:0
  ds_read_b128 v[100:103], v6 offset:18432
  ds_read_b128 v[104:107], v6 offset:36864
  ds_read_b128 v[108:111], v6 offset:55296
  s_waitcnt lgkmcnt(7)
  s_waitcnt vmcnt(17)
  v_mfma_f32_16x16x32_bf16 v[112:115], v[8:11], v[80:83], 0
  ds_read_b128 v[80:83], v5 offset:128
  s_waitcnt lgkmcnt(7)
  v_mfma_f32_16x16x32_bf16 v[116:119], v[8:11], v[84:87], 0
  ds_read_b128 v[84:87], v5 offset:18560
  s_waitcnt lgkmcnt(7)
  v_mfma_f32_16x16x32_bf16 v[120:123], v[8:11], v[88:91], 0
  ds_read_b128 v[88:91], v5 offset:36992
  s_waitcnt lgkmcnt(7)
  v_mfma_f32_16x16x32_bf16 v[124:127], v[8:11], v[92:95], 0
  ds_read_b128 v[92:95], v5 offset:55424
  s_waitcnt lgkmcnt(7)
  s_waitcnt vmcnt(16)
  v_mfma_f32_16x16x32_bf16 v[112:115], v[12:15], v[96:99], v[112:115]
  ds_read_b128 v[96:99], v6 offset:128
  s_waitcnt lgkmcnt(7)
  v_mfma_f32_16x16x32_bf16 v[116:119], v[12:15], v[100:103], v[116:119]
  ds_read_b128 v[100:103], v6 offset:18560
  s_waitcnt lgkmcnt(7)
  v_mfma_f32_16x16x32_bf16 v[120:123], v[12:15], v[104:107], v[120:123]
  ds_read_b128 v[104:107], v6 offset:36992
  s_waitcnt lgkmcnt(7)
  v_mfma_f32_16x16x32_bf16 v[124:127], v[12:15], v[108:111], v[124:127]
  ds_read_b128 v[108:111], v6 offset:55424
  s_waitcnt lgkmcnt(7)
  s_waitcnt vmcnt(15)
  v_mfma_f32_16x16x32_bf16 v[112:115], v[16:19], v[80:83], v[112:115]
  ds_read_b128 v[80:83], v5 offset:256
  s_waitcnt lgkmcnt(7)
  v_mfma_f32_16x16x32_bf16 v[116:119], v[16:19], v[84:87], v[116:119]
  ds_read_b128 v[84:87], v5 offset:18688
  s_waitcnt lgkmcnt(7)
  v_mfma_f32_16x16x32_bf16 v[120:123], v[16:19], v[88:91], v[120:123]
  ds_read_b128 v[88:91], v5 offset:37120
  s_waitcnt lgkmcnt(7)
  v_mfma_f32_16x16x32_bf16 v[124:127], v[16:19], v[92:95], v[124:127]
  ds_read_b128 v[92:95], v5 offset:55552
  s_waitcnt lgkmcnt(7)
  s_waitcnt vmcnt(14)
  v_mfma_f32_16x16x32_bf16 v[112:115], v[20:23], v[96:99], v[112:115]
  ds_read_b128 v[96:99], v6 offset:256
  s_waitcnt lgkmcnt(7)
  v_mfma_f32_16x16x32_bf16 v[116:119], v[20:23], v[100:103], v[116:119]
  ds_read_b128 v[100:103], v6 offset:18688
  s_waitcnt lgkmcnt(7)
  v_mfma_f32_16x16x32_bf16 v[120:123], v[20:23], v[104:107], v[120:123]
  ds_read_b128 v[104:107], v6 offset:37120
  s_waitcnt lgkmcnt(7)
  v_mfma_f32_16x16x32_bf16 v[124:127], v[20:23], v[108:111], v[124:127]
  ds_read_b128 v[108:111], v6 offset:55552
  s_waitcnt lgkmcnt(7)
  s_waitcnt vmcnt(13)
  v_mfma_f32_16x16x32_bf16 v[112:115], v[24:27], v[80:83], v[112:115]
  ds_read_b128 v[80:83], v5 offset:384
  s_waitcnt lgkmcnt(7)
  v_mfma_f32_16x16x32_bf16 v[116:119], v[24:27], v[84:87], v[116:119]
  ds_read_b128 v[84:87], v5 offset:18816
  s_waitcnt lgkmcnt(7)
  v_mfma_f32_16x16x32_bf16 v[120:123], v[24:27], v[88:91], v[120:123]
  ds_read_b128 v[88:91], v5 offset:37248
  s_waitcnt lgkmcnt(7)
  v_mfma_f32_16x16x32_bf16 v[124:127], v[24:27], v[92:95], v[124:127]
  ds_read_b128 v[92:95], v5 offset:55680
  s_waitcnt lgkmcnt(7)
  s_waitcnt vmcnt(12)
  v_mfma_f32_16x16x32_bf16 v[112:115], v[28:31], v[96:99], v[112:115]
  ds_read_b128 v[96:99], v6 offset:384
  s_waitcnt lgkmcnt(7)
  v_mfma_f32_16x16x32_bf16 v[116:119], v[28:31], v[100:103], v[116:119]
  ds_read_b128 v[100:103], v6 offset:18816
  s_waitcnt lgkmcnt(7)
  v_mfma_f32_16x16x32_bf16 v[120:123], v[28:31], v[104:107], v[120:123]
  ds_read_b128 v[104:107], v6 offset:37248
  s_waitcnt lgkmcnt(7)
  v_mfma_f32_16x16x32_bf16 v[124:127], v[28:31], v[108:111], v[124:127]
  ds_read_b128 v[108:111], v6 offset:55680
  s_waitcnt lgkmcnt(7)
  s_waitcnt vmcnt(11)
  v_mfma_f32_16x16x32_bf16 v[112:115], v[32:35], v[80:83], v[112:115]
  ds_read_b128 v[80:83], v5 offset:512
  s_waitcnt lgkmcnt(7)
  v_mfma_f32_16x16x32_bf16 v[116:119], v[32:35], v[84:87], v[116:119]
  ds_read_b128 v[84:87], v5 offset:18944
  s_waitcnt lgkmcnt(7)
  v_mfma_f32_16x16x32_bf16 v[120:123], v[32:35], v[88:91], v[120:123]
  ds_read_b128 v[88:91], v5 offset:37376
  s_waitcnt lgkmcnt(7)
  v_mfma_f32_16x16x32_bf16 v[124:127], v[32:35], v[92:95], v[124:127]
  ds_read_b128 v[92:95], v5 offset:55808
  s_waitcnt lgkmcnt(7)
  s_waitcnt vmcnt(10)
  v_mfma_f32_16x16x32_bf16 v[112:115], v[36:39], v[96:99], v[112:115]
  ds_read_b128 v[96:99], v6 offset:512
  s_waitcnt lgkmcnt(7)
  v_mfma_f32_16x16x32_bf16 v[116:119], v[36:39], v[100:103], v[116:119]
  ds_read_b128 v[100:103], v6 offset:18944
  s_waitcnt lgkmcnt(7)
  v_mfma_f32_16x16x32_bf16 v[120:123], v[36:39], v[104:107], v[120:123]
  ds_read_b128 v[104:107], v6 offset:37376
  s_waitcnt lgkmcnt(7)
  v_mfma_f32_16x16x32_bf16 v[124:127], v[36:39], v[108:111], v[124:127]
  ds_read_b128 v[108:111], v6 offset:55808
  s_waitcnt lgkmcnt(7)
  s_waitcnt vmcnt(9)
  v_mfma_f32_16x16x32_bf16 v[112:115], v[40:43], v[80:83], v[112:115]
  ds_read_b128 v[80:83], v5 offset:640
  s_waitcnt lgkmcnt(7)
  v_mfma_f32_16x16x32_bf16 v[116:119], v[40:43], v[84:87], v[116:119]
  ds_read_b128 v[84:87], v5 offset:19072
  s_waitcnt lgkmcnt(7)
  v_mfma_f32_16x16x32_bf16 v[120:123], v[40:43], v[88:91], v[120:123]
  ds_read_b128 v[88:91], v5 offset:37504
  s_waitcnt lgkmcnt(7)
  v_mfma_f32_16x16x32_bf16 v[124:127], v[40:43], v[92:95], v[124:127]
  ds_read_b128 v[92:95], v5 offset:55936
  s_waitcnt lgkmcnt(7)
  s_waitcnt vmcnt(8)
  v_mfma_f32_16x16x32_bf16 v[112:115], v[44:47], v[96:99], v[112:115]
  ds_read_b128 v[96:99], v6 offset:640
  s_waitcnt lgkmcnt(7)
  v_mfma_f32_16x16x32_bf16 v[116:119], v[44:47], v[100:103], v[116:119]
  ds_read_b128 v[100:103], v6 offset:19072
  s_waitcnt lgkmcnt(7)
  v_mfma_f32_16x16x32_bf16 v[120:123], v[44:47], v[104:107], v[120:123]
  ds_read_b128 v[104:107], v6 offset:37504
  s_waitcnt lgkmcnt(7)
  v_mfma_f32_16x16x32_bf16 v[124:127], v[44:47], v[108:111], v[124:127]
  ds_read_b128 v[108:111], v6 offset:55936
  s_waitcnt lgkmcnt(7)
  s_waitcnt vmcnt(7)
  v_mfma_f32_16x16x32_bf16 v[112:115], v[48:51], v[80:83], v[112:115]
  ds_read_b128 v[80:83], v5 offset:768
  s_waitcnt lgkmcnt(7)
  v_mfma_f32_16x16x32_bf16 v[116:119], v[48:51], v[84:87], v[116:119]
  ds_read_b128 v[84:87], v5 offset:19200
  s_waitcnt lgkmcnt(7)
  v_mfma_f32_16x16x32_bf16 v[120:123], v[48:51], v[88:91], v[120:123]
  ds_read_b128 v[88:91], v5 offset:37632
  s_waitcnt lgkmcnt(7)
  v_mfma_f32_16x16x32_bf16 v[124:127], v[48:51], v[92:95], v[124:127]
  ds_read_b128 v[92:95], v5 offset:56064
  s_waitcnt lgkmcnt(7)
  s_waitcnt vmcnt(6)
  v_mfma_f32_16x16x32_bf16 v[112:115], v[52:55], v[96:99], v[112:115]
  ds_read_b128 v[96:99], v6 offset:768
  s_waitcnt lgkmcnt(7)
  v_mfma_f32_16x16x32_bf16 v[116:119], v[52:55], v[100:103], v[116:119]
  ds_read_b128 v[100:103], v6 offset:19200
  s_waitcnt lgkmcnt(7)
  v_mfma_f32_16x16x32_bf16 v[120:123], v[52:55], v[104:107], v[120:123]
  ds_read_b128 v[104:107], v6 offset:37632
  s_waitcnt lgkmcnt(7)
  v_mfma_f32_16x16x32_bf16 v[124:127], v[52:55], v[108:111], v[124:127]
  ds_read_b128 v[108:111], v6 offset:56064
  s_waitcnt lgkmcnt(7)
  s_waitcnt vmcnt(5)
  v_mfma_f32_16x16x32_bf16 v[112:115], v[56:59], v[80:83], v[112:115]
  ds_read_b128 v[80:83], v5 offset:896
  s_waitcnt lgkmcnt(7)
  v_mfma_f32_16x16x32_bf16 v[116:119], v[56:59], v[84:87], v[116:119]
  ds_read_b128 v[84:87], v5 offset:19328
  s_waitcnt lgkmcnt(7)
  v_mfma_f32_16x16x32_bf16 v[120:123], v[56:59], v[88:91], v[120:123]
  ds_read_b128 v[88:91], v5 offset:37760
  s_waitcnt lgkmcnt(7)
  v_mfma_f32_16x16x32_bf16 v[124:127], v[56:59], v[92:95], v[124:127]
  ds_read_b128 v[92:95], v5 offset:56192
  s_waitcnt lgkmcnt(7)
  s_waitcnt vmcnt(4)
  v_mfma_f32_16x16x32_bf16 v[112:115], v[60:63], v[96:99], v[112:115]
  ds_read_b128 v[96:99], v6 offset:896
  s_waitcnt lgkmcnt(7)
  v_mfma_f32_16x16x32_bf16 v[116:119], v[60:63], v[100:103], v[116:119]
  ds_read_b128 v[100:103], v6 offset:19328
  s_waitcnt lgkmcnt(7)
  v_mfma_f32_16x16x32_bf16 v[120:123], v[60:63], v[104:107], v[120:123]
  ds_read_b128 v[104:107], v6 offset:37760
  s_waitcnt lgkmcnt(7)
  v_mfma_f32_16x16x32_bf16 v[124:127], v[60:63], v[108:111], v[124:127]
  ds_read_b128 v[108:111], v6 offset:56192
  s_waitcnt lgkmcnt(7)
  s_waitcnt vmcnt(3)
  v_mfma_f32_16x16x32_bf16 v[112:115], v[64:67], v[80:83], v[112:115]
  ds_read_b128 v[80:83], v5 offset:1024
  s_waitcnt lgkmcnt(7)
  v_mfma_f32_16x16x32_bf16 v[116:119], v[64:67], v[84:87], v[116:119]
  ds_read_b128 v[84:87], v5 offset:19456
  s_waitcnt lgkmcnt(7)
  v_mfma_f32_16x16x32_bf16 v[120:123], v[64:67], v[88:91], v[120:123]
  ds_read_b128 v[88:91], v5 offset:37888
  s_waitcnt lgkmcnt(7)
  v_mfma_f32_16x16x32_bf16 v[124:127], v[64:67], v[92:95], v[124:127]
  ds_read_b128 v[92:95], v5 offset:56320
  s_waitcnt lgkmcnt(7)
  s_waitcnt vmcnt(2)
  v_mfma_f32_16x16x32_bf16 v[112:115], v[68:71], v[96:99], v[112:115]
  ds_read_b128 v[96:99], v6 offset:1024
  s_waitcnt lgkmcnt(7)
  v_mfma_f32_16x16x32_bf16 v[116:119], v[68:71], v[100:103], v[116:119]
  ds_read_b128 v[100:103], v6 offset:19456
  s_waitcnt lgkmcnt(7)
  v_mfma_f32_16x16x32_bf16 v[120:123], v[68:71], v[104:107], v[120:123]
  ds_read_b128 v[104:107], v6 offset:37888
  s_waitcnt lgkmcnt(7)
  v_mfma_f32_16x16x32_bf16 v[124:127], v[68:71], v[108:111], v[124:127]
  ds_read_b128 v[108:111], v6 offset:56320
  s_waitcnt lgkmcnt(7)
  s_waitcnt vmcnt(1)
  v_mfma_f32_16x16x32_bf16 v[112:115], v[72:75], v[80:83], v[112:115]
  s_waitcnt lgkmcnt(6)
  v_mfma_f32_16x16x32_bf16 v[116:119], v[72:75], v[84:87], v[116:119]
  s_waitcnt lgkmcnt(5)
  v_mfma_f32_16x16x32_bf16 v[120:123], v[72:75], v[88:91], v[120:123]
  s_waitcnt lgkmcnt(4)
  v_mfma_f32_16x16x32_bf16 v[124:127], v[72:75], v[92:95], v[124:127]
  s_waitcnt lgkmcnt(3)
  s_waitcnt vmcnt(0)
  v_mfma_f32_16x16x32_bf16 v[112:115], v[76:79], v[96:99], v[112:115]
  s_waitcnt lgkmcnt(2)
  v_mfma_f32_16x16x32_bf16 v[116:119], v[76:79], v[100:103], v[116:119]
  s_waitcnt lgkmcnt(1)
  v_mfma_f32_16x16x32_bf16 v[120:123], v[76:79], v[104:107], v[120:123]
  s_waitcnt lgkmcnt(0)
  v_mfma_f32_16x16x32_bf16 v[124:127], v[76:79], v[108:111], v[124:127]
  s_nop 7
  s_cmp_ge_u32 s23, 36
  s_cbranch_scc1 L_k2_k
  s_add_u32 s24, s20, 1437696
  s_addc_u32 s25, s21, 0
  s_mov_b32 s26, 2359296
  s_mov_b32 s27, 0x20000
  s_mov_b32 s40, 0x3eae1a93
  v_mul_u32_u24 v7, 1152, v3
  v_lshl_add_u32 v7, v4, 3, v7
  s_mul_i32 s41, s22, 73728
  s_lshl_b32 s42, s23, 5
  s_add_u32 s41, s41, s42
  v_mul_f32 v112, s40, v112
  v_mul_f32 v113, s40, v113
  v_mul_f32 v114, s40, v114
  v_mul_f32 v115, s40, v115
  v_mul_f32 v116, s40, v116
  v_mul_f32 v117, s40, v117
  v_mul_f32 v118, s40, v118
  v_mul_f32 v119, s40, v119
  v_mul_f32 v120, s40, v120
  v_mul_f32 v121, s40, v121
  v_mul_f32 v122, s40, v122
  v_mul_f32 v123, s40, v123
  v_mul_f32 v124, s40, v124
  v_mul_f32 v125, s40, v125
  v_mul_f32 v126, s40, v126
  v_mul_f32 v127, s40, v127
  v_cvt_pk_bf16_f32 v80, v112, v113
  v_cvt_pk_bf16_f32 v81, v114, v115
  v_cvt_pk_bf16_f32 v82, v116, v117
  v_cvt_pk_bf16_f32 v83, v118, v119
  v_cvt_pk_bf16_f32 v84, v120, v121
  v_cvt_pk_bf16_f32 v85, v122, v123
  v_cvt_pk_bf16_f32 v86, v124, v125
  v_cvt_pk_bf16_f32 v87, v126, v127
  buffer_store_dwordx2 v[80:81], v7, s[24:27], s41 offen
  s_add_u32 s41, s41, 18432
  buffer_store_dwordx2 v[82:83], v7, s[24:27], s41 offen
  s_add_u32 s41, s41, 18432
  buffer_store_dwordx2 v[84:85], v7, s[24:27], s41 offen
  s_add_u32 s41, s41, 18432
  buffer_store_dwordx2 v[86:87], v7, s[24:27], s41 offen
  s_branch L_k2_fin
L_k2_k:
  s_add_u32 s24, s20, 3796992
  s_addc_u32 s25, s21, 0
  s_mov_b32 s26, 163840
  s_mov_b32 s27, 0x20000
  s_add_u32 s28, s20, 3960832
  s_addc_u32 s29, s21, 0
  s_mov_b32 s30, 512
  s_mov_b32 s31, 0x20000
  s_mul_i32 s41, s22, 4992
  s_add_u32 s43, s41, 2496
  v_cvt_pk_bf16_f32 v80, v112, v113
  v_cvt_pk_bf16_f32 v81, v114, v115
  v_cvt_pk_bf16_f32 v82, v116, v117
  v_cvt_pk_bf16_f32 v83, v118, v119
  v_cvt_pk_bf16_f32 v84, v120, v121
  v_cvt_pk_bf16_f32 v85, v122, v123
  v_cvt_pk_bf16_f32 v86, v124, v125
  v_cvt_pk_bf16_f32 v87, v126, v127
  v_mov_b32 v90, 0
  v_dot2c_f32_bf16 v90, v80, v80
  v_dot2c_f32_bf16 v90, v81, v81
  v_mov_b32 v91, 0
  v_dot2c_f32_bf16 v91, v82, v82
  v_dot2c_f32_bf16 v91, v83, v83
  v_mov_b32 v92, 0
  v_dot2c_f32_bf16 v92, v84, v84
  v_dot2c_f32_bf16 v92, v85, v85
  v_mov_b32 v93, 0
  v_dot2c_f32_bf16 v93, v86, v86
  v_dot2c_f32_bf16 v93, v87, v87
  v_xor_b32 v94, 16, v1
  v_lshlrev_b32 v94, 2, v94
  v_xor_b32 v95, 32, v1
  v_lshlrev_b32 v95, 2, v95
  ds_bpermute_b32 v96, v94, v90
  ds_bpermute_b32 v97, v94, v91
  ds_bpermute_b32 v98, v94, v92
  ds_bpermute_b32 v99, v94, v93
  s_waitcnt lgkmcnt(0)
  v_add_f32 v90, v90, v96
  v_add_f32 v91, v91, v97
  v_add_f32 v92, v92, v98
  v_add_f32 v93, v93, v99
  ds_bpermute_b32 v96, v95, v90
  ds_bpermute_b32 v97, v95, v91
  ds_bpermute_b32 v98, v95, v92
  ds_bpermute_b32 v99, v95, v93
  s_waitcnt lgkmcnt(0)
  v_add_f32 v90, v90, v96
  v_add_f32 v91, v91, v97
  v_add_f32 v92, v92, v98
  v_add_f32 v93, v93, v99
  v_max_f32 v90, v90, v91
  v_max3_f32 v90, v90, v92, v93
  s_nop 1
  v_max_f32_dpp v90, v90, v90 row_ror:1 row_mask:0xf bank_mask:0xf
  s_nop 1
  v_max_f32_dpp v90, v90, v90 row_ror:2 row_mask:0xf bank_mask:0xf
  s_nop 1
  v_max_f32_dpp v90, v90, v90 row_ror:4 row_mask:0xf bank_mask:0xf
  s_nop 1
  v_max_f32_dpp v90, v90, v90 row_ror:8 row_mask:0xf bank_mask:0xf
  s_lshl_b32 s42, s22, 4
  s_cmp_eq_u32 s23, 37
  s_cbranch_scc1 L_k2_k1
  v_lshrrev_b32 v8, 1, v4
  v_and_b32 v9, 1, v4
  v_lshlrev_b32 v7, 4, v3
  v_lshl_add_u32 v7, v8, 9, v7
  v_lshl_add_u32 v7, v9, 3, v7
  buffer_store_dwordx2 v[80:81], v7, s[24:27], s41 offen
  buffer_store_dwordx2 v[82:83], v7, s[24:27], s41 offen offset:256
  buffer_store_dwordx2 v[84:85], v7, s[24:27], s43 offen
  buffer_store_dwordx2 v[86:87], v7, s[24:27], s43 offen offset:256
  v_mov_b32 v7, 0
  v_cmp_eq_u32 vcc, 0, v1
  s_and_saveexec_b64 s[44:45], vcc
  buffer_store_dword v90, v7, s[28:31], s42 offen
  s_branch L_k2_fin
L_k2_k1:
  v_mov_b32 v81, 0x3f803f80
  v_mov_b32 v83, 0x3f803f80
  v_mov_b32 v85, 0x3f803f80
  v_mov_b32 v87, 0x3f803f80
  v_lshlrev_b32 v7, 3, v3
  v_cmp_gt_u32 vcc, 16, v1
  s_and_saveexec_b64 s[44:45], vcc
  buffer_store_dwordx2 v[80:81], v7, s[24:27], s41 offen offset:1024
  buffer_store_dwordx2 v[82:83], v7, s[24:27], s41 offen offset:1152
  buffer_store_dwordx2 v[84:85], v7, s[24:27], s43 offen offset:1024
  buffer_store_dwordx2 v[86:87], v7, s[24:27], s43 offen offset:1152
  v_mov_b32 v7, 0
  v_cmp_eq_u32 vcc, 0, v1
  s_and_saveexec_b64 s[44:45], vcc
  buffer_store_dword v90, v7, s[28:31], s42 offen offset:4
  s_branch L_k2_fin
L_k2_v:
  ds_read_b128 v[80:83], v5 offset:0
  ds_read_b128 v[84:87], v5 offset:18432
  ds_read_b128 v[88:91], v5 offset:36864
  ds_read_b128 v[92:95], v5 offset:55296
  ds_read_b128 v[96:99], v6 offset:0
  ds_read_b128 v[100:103], v6 offset:18432
  ds_read_b128 v[104:107], v6 offset:36864
  ds_read_b128 v[108:111], v6 offset:55296
  s_waitcnt lgkmcnt(7)
  s_waitcnt vmcnt(17)
  v_mfma_f32_16x16x32_bf16 v[112:115], v[80:83], v[8:11], 0
  ds_read_b128 v[80:83], v5 offset:128
  s_waitcnt lgkmcnt(7)
  v_mfma_f32_16x16x32_bf16 v[116:119], v[84:87], v[8:11], 0
  ds_read_b128 v[84:87], v5 offset:18560
  s_waitcnt lgkmcnt(7)
  v_mfma_f32_16x16x32_bf16 v[120:123], v[88:91], v[8:11], 0
  ds_read_b128 v[88:91], v5 offset:36992
  s_waitcnt lgkmcnt(7)
  v_mfma_f32_16x16x32_bf16 v[124:127], v[92:95], v[8:11], 0
  ds_read_b128 v[92:95], v5 offset:55424
  s_waitcnt lgkmcnt(7)
  s_waitcnt vmcnt(16)
  v_mfma_f32_16x16x32_bf16 v[112:115], v[96:99], v[12:15], v[112:115]
  ds_read_b128 v[96:99], v6 offset:128
  s_waitcnt lgkmcnt(7)
  v_mfma_f32_16x16x32_bf16 v[116:119], v[100:103], v[12:15], v[116:119]
  ds_read_b128 v[100:103], v6 offset:18560
  s_waitcnt lgkmcnt(7)
  v_mfma_f32_16x16x32_bf16 v[120:123], v[104:107], v[12:15], v[120:123]
  ds_read_b128 v[104:107], v6 offset:36992
  s_waitcnt lgkmcnt(7)
  v_mfma_f32_16x16x32_bf16 v[124:127], v[108:111], v[12:15], v[124:127]
  ds_read_b128 v[108:111], v6 offset:55424
  s_waitcnt lgkmcnt(7)
  s_waitcnt vmcnt(15)
  v_mfma_f32_16x16x32_bf16 v[112:115], v[80:83], v[16:19], v[112:115]
  ds_read_b128 v[80:83], v5 offset:256
  s_waitcnt lgkmcnt(7)
  v_mfma_f32_16x16x32_bf16 v[116:119], v[84:87], v[16:19], v[116:119]
  ds_read_b128 v[84:87], v5 offset:18688
  s_waitcnt lgkmcnt(7)
  v_mfma_f32_16x16x32_bf16 v[120:123], v[88:91], v[16:19], v[120:123]
  ds_read_b128 v[88:91], v5 offset:37120
  s_waitcnt lgkmcnt(7)
  v_mfma_f32_16x16x32_bf16 v[124:127], v[92:95], v[16:19], v[124:127]
  ds_read_b128 v[92:95], v5 offset:55552
  s_waitcnt lgkmcnt(7)
  s_waitcnt vmcnt(14)
  v_mfma_f32_16x16x32_bf16 v[112:115], v[96:99], v[20:23], v[112:115]
  ds_read_b128 v[96:99], v6 offset:256
  s_waitcnt lgkmcnt(7)
  v_mfma_f32_16x16x32_bf16 v[116:119], v[100:103], v[20:23], v[116:119]
  ds_read_b128 v[100:103], v6 offset:18688
  s_waitcnt lgkmcnt(7)
  v_mfma_f32_16x16x32_bf16 v[120:123], v[104:107], v[20:23], v[120:123]
  ds_read_b128 v[104:107], v6 offset:37120
  s_waitcnt lgkmcnt(7)
  v_mfma_f32_16x16x32_bf16 v[124:127], v[108:111], v[20:23], v[124:127]
  ds_read_b128 v[108:111], v6 offset:55552
  s_waitcnt lgkmcnt(7)
  s_waitcnt vmcnt(13)
  v_mfma_f32_16x16x32_bf16 v[112:115], v[80:83], v[24:27], v[112:115]
  ds_read_b128 v[80:83], v5 offset:384
  s_waitcnt lgkmcnt(7)
  v_mfma_f32_16x16x32_bf16 v[116:119], v[84:87], v[24:27], v[116:119]
  ds_read_b128 v[84:87], v5 offset:18816
  s_waitcnt lgkmcnt(7)
  v_mfma_f32_16x16x32_bf16 v[120:123], v[88:91], v[24:27], v[120:123]
  ds_read_b128 v[88:91], v5 offset:37248
  s_waitcnt lgkmcnt(7)
  v_mfma_f32_16x16x32_bf16 v[124:127], v[92:95], v[24:27], v[124:127]
  ds_read_b128 v[92:95], v5 offset:55680
  s_waitcnt lgkmcnt(7)
  s_waitcnt vmcnt(12)
  v_mfma_f32_16x16x32_bf16 v[112:115], v[96:99], v[28:31], v[112:115]
  ds_read_b128 v[96:99], v6 offset:384
  s_waitcnt lgkmcnt(7)
  v_mfma_f32_16x16x32_bf16 v[116:119], v[100:103], v[28:31], v[116:119]
  ds_read_b128 v[100:103], v6 offset:18816
  s_waitcnt lgkmcnt(7)
  v_mfma_f32_16x16x32_bf16 v[120:123], v[104:107], v[28:31], v[120:123]
  ds_read_b128 v[104:107], v6 offset:37248
  s_waitcnt lgkmcnt(7)
  v_mfma_f32_16x16x32_bf16 v[124:127], v[108:111], v[28:31], v[124:127]
  ds_read_b128 v[108:111], v6 offset:55680
  s_waitcnt lgkmcnt(7)
  s_waitcnt vmcnt(11)
  v_mfma_f32_16x16x32_bf16 v[112:115], v[80:83], v[32:35], v[112:115]
  ds_read_b128 v[80:83], v5 offset:512
  s_waitcnt lgkmcnt(7)
  v_mfma_f32_16x16x32_bf16 v[116:119], v[84:87], v[32:35], v[116:119]
  ds_read_b128 v[84:87], v5 offset:18944
  s_waitcnt lgkmcnt(7)
  v_mfma_f32_16x16x32_bf16 v[120:123], v[88:91], v[32:35], v[120:123]
  ds_read_b128 v[88:91], v5 offset:37376
  s_waitcnt lgkmcnt(7)
  v_mfma_f32_16x16x32_bf16 v[124:127], v[92:95], v[32:35], v[124:127]
  ds_read_b128 v[92:95], v5 offset:55808
  s_waitcnt lgkmcnt(7)
  s_waitcnt vmcnt(10)
  v_mfma_f32_16x16x32_bf16 v[112:115], v[96:99], v[36:39], v[112:115]
  ds_read_b128 v[96:99], v6 offset:512
  s_waitcnt lgkmcnt(7)
  v_mfma_f32_16x16x32_bf16 v[116:119], v[100:103], v[36:39], v[116:119]
  ds_read_b128 v[100:103], v6 offset:18944
  s_waitcnt lgkmcnt(7)
  v_mfma_f32_16x16x32_bf16 v[120:123], v[104:107], v[36:39], v[120:123]
  ds_read_b128 v[104:107], v6 offset:37376
  s_waitcnt lgkmcnt(7)
  v_mfma_f32_16x16x32_bf16 v[124:127], v[108:111], v[36:39], v[124:127]
  ds_read_b128 v[108:111], v6 offset:55808
  s_waitcnt lgkmcnt(7)
  s_waitcnt vmcnt(9)
  v_mfma_f32_16x16x32_bf16 v[112:115], v[80:83], v[40:43], v[112:115]
  ds_read_b128 v[80:83], v5 offset:640
  s_waitcnt lgkmcnt(7)
  v_mfma_f32_16x16x32_bf16 v[116:119], v[84:87], v[40:43], v[116:119]
  ds_read_b128 v[84:87], v5 offset:19072
  s_waitcnt lgkmcnt(7)
  v_mfma_f32_16x16x32_bf16 v[120:123], v[88:91], v[40:43], v[120:123]
  ds_read_b128 v[88:91], v5 offset:37504
  s_waitcnt lgkmcnt(7)
  v_mfma_f32_16x16x32_bf16 v[124:127], v[92:95], v[40:43], v[124:127]
  ds_read_b128 v[92:95], v5 offset:55936
  s_waitcnt lgkmcnt(7)
  s_waitcnt vmcnt(8)
  v_mfma_f32_16x16x32_bf16 v[112:115], v[96:99], v[44:47], v[112:115]
  ds_read_b128 v[96:99], v6 offset:640
  s_waitcnt lgkmcnt(7)
  v_mfma_f32_16x16x32_bf16 v[116:119], v[100:103], v[44:47], v[116:119]
  ds_read_b128 v[100:103], v6 offset:19072
  s_waitcnt lgkmcnt(7)
  v_mfma_f32_16x16x32_bf16 v[120:123], v[104:107], v[44:47], v[120:123]
  ds_read_b128 v[104:107], v6 offset:37504
  s_waitcnt lgkmcnt(7)
  v_mfma_f32_16x16x32_bf16 v[124:127], v[108:111], v[44:47], v[124:127]
  ds_read_b128 v[108:111], v6 offset:55936
  s_waitcnt lgkmcnt(7)
  s_waitcnt vmcnt(7)
  v_mfma_f32_16x16x32_bf16 v[112:115], v[80:83], v[48:51], v[112:115]
  ds_read_b128 v[80:83], v5 offset:768
  s_waitcnt lgkmcnt(7)
  v_mfma_f32_16x16x32_bf16 v[116:119], v[84:87], v[48:51], v[116:119]
  ds_read_b128 v[84:87], v5 offset:19200
  s_waitcnt lgkmcnt(7)
  v_mfma_f32_16x16x32_bf16 v[120:123], v[88:91], v[48:51], v[120:123]
  ds_read_b128 v[88:91], v5 offset:37632
  s_waitcnt lgkmcnt(7)
  v_mfma_f32_16x16x32_bf16 v[124:127], v[92:95], v[48:51], v[124:127]
  ds_read_b128 v[92:95], v5 offset:56064
  s_waitcnt lgkmcnt(7)
  s_waitcnt vmcnt(6)
  v_mfma_f32_16x16x32_bf16 v[112:115], v[96:99], v[52:55], v[112:115]
  ds_read_b128 v[96:99], v6 offset:768
  s_waitcnt lgkmcnt(7)
  v_mfma_f32_16x16x32_bf16 v[116:119], v[100:103], v[52:55], v[116:119]
  ds_read_b128 v[100:103], v6 offset:19200
  s_waitcnt lgkmcnt(7)
  v_mfma_f32_16x16x32_bf16 v[120:123], v[104:107], v[52:55], v[120:123]
  ds_read_b128 v[104:107], v6 offset:37632
  s_waitcnt lgkmcnt(7)
  v_mfma_f32_16x16x32_bf16 v[124:127], v[108:111], v[52:55], v[124:127]
  ds_read_b128 v[108:111], v6 offset:56064
  s_waitcnt lgkmcnt(7)
  s_waitcnt vmcnt(5)
  v_mfma_f32_16x16x32_bf16 v[112:115], v[80:83], v[56:59], v[112:115]
  ds_read_b128 v[80:83], v5 offset:896
  s_waitcnt lgkmcnt(7)
  v_mfma_f32_16x16x32_bf16 v[116:119], v[84:87], v[56:59], v[116:119]
  ds_read_b128 v[84:87], v5 offset:19328
  s_waitcnt lgkmcnt(7)
  v_mfma_f32_16x16x32_bf16 v[120:123], v[88:91], v[56:59], v[120:123]
  ds_read_b128 v[88:91], v5 offset:37760
  s_waitcnt lgkmcnt(7)
  v_mfma_f32_16x16x32_bf16 v[124:127], v[92:95], v[56:59], v[124:127]
  ds_read_b128 v[92:95], v5 offset:56192
  s_waitcnt lgkmcnt(7)
  s_waitcnt vmcnt(4)
  v_mfma_f32_16x16x32_bf16 v[112:115], v[96:99], v[60:63], v[112:115]
  ds_read_b128 v[96:99], v6 offset:896
  s_waitcnt lgkmcnt(7)
  v_mfma_f32_16x16x32_bf16 v[116:119], v[100:103], v[60:63], v[116:119]
  ds_read_b128 v[100:103], v6 offset:19328
  s_waitcnt lgkmcnt(7)
  v_mfma_f32_16x16x32_bf16 v[120:123], v[104:107], v[60:63], v[120:123]
  ds_read_b128 v[104:107], v6 offset:37760
  s_waitcnt lgkmcnt(7)
  v_mfma_f32_16x16x32_bf16 v[124:127], v[108:111], v[60:63], v[124:127]
  ds_read_b128 v[108:111], v6 offset:56192
  s_waitcnt lgkmcnt(7)
  s_waitcnt vmcnt(3)
  v_mfma_f32_16x16x32_bf16 v[112:115], v[80:83], v[64:67], v[112:115]
  ds_read_b128 v[80:83], v5 offset:1024
  s_waitcnt lgkmcnt(7)
  v_mfma_f32_16x16x32_bf16 v[116:119], v[84:87], v[64:67], v[116:119]
  ds_read_b128 v[84:87], v5 offset:19456
  s_waitcnt lgkmcnt(7)
  v_mfma_f32_16x16x32_bf16 v[120:123], v[88:91], v[64:67], v[120:123]
  ds_read_b128 v[88:91], v5 offset:37888
  s_waitcnt lgkmcnt(7)
  v_mfma_f32_16x16x32_bf16 v[124:127], v[92:95], v[64:67], v[124:127]
  ds_read_b128 v[92:95], v5 offset:56320
  s_waitcnt lgkmcnt(7)
  s_waitcnt vmcnt(2)
  v_mfma_f32_16x16x32_bf16 v[112:115], v[96:99], v[68:71], v[112:115]
  ds_read_b128 v[96:99], v6 offset:1024
  s_waitcnt lgkmcnt(7)
  v_mfma_f32_16x16x32_bf16 v[116:119], v[100:103], v[68:71], v[116:119]
  ds_read_b128 v[100:103], v6 offset:19456
  s_waitcnt lgkmcnt(7)
  v_mfma_f32_16x16x32_bf16 v[120:123], v[104:107], v[68:71], v[120:123]
  ds_read_b128 v[104:107], v6 offset:37888
  s_waitcnt lgkmcnt(7)
  v_mfma_f32_16x16x32_bf16 v[124:127], v[108:111], v[68:71], v[124:127]
  ds_read_b128 v[108:111], v6 offset:56320
  s_waitcnt lgkmcnt(7)
  s_waitcnt vmcnt(1)
  v_mfma_f32_16x16x32_bf16 v[112:115], v[80:83], v[72:75], v[112:115]
  s_waitcnt lgkmcnt(6)
  v_mfma_f32_16x16x32_bf16 v[116:119], v[84:87], v[72:75], v[116:119]
  s_waitcnt lgkmcnt(5)
  v_mfma_f32_16x16x32_bf16 v[120:123], v[88:91], v[72:75], v[120:123]
  s_waitcnt lgkmcnt(4)
  v_mfma_f32_16x16x32_bf16 v[124:127], v[92:95], v[72:75], v[124:127]
  s_waitcnt lgkmcnt(3)
  s_waitcnt vmcnt(0)
  v_mfma_f32_16x16x32_bf16 v[112:115], v[96:99], v[76:79], v[112:115]
  s_waitcnt lgkmcnt(2)
  v_mfma_f32_16x16x32_bf16 v[116:119], v[100:103], v[76:79], v[116:119]
  s_waitcnt lgkmcnt(1)
  v_mfma_f32_16x16x32_bf16 v[120:123], v[104:107], v[76:79], v[120:123]
  s_waitcnt lgkmcnt(0)
  v_mfma_f32_16x16x32_bf16 v[124:127], v[108:111], v[76:79], v[124:127]
  s_nop 7
  s_add_u32 s24, s20, 3796992
  s_addc_u32 s25, s21, 0
  s_mov_b32 s26, 163840
  s_mov_b32 s27, 0x20000
  s_add_u32 s28, s20, 3960832
  s_addc_u32 s29, s21, 0
  s_mov_b32 s30, 512
  s_mov_b32 s31, 0x20000
  s_mul_i32 s41, s22, 4992
  s_add_u32 s43, s41, 2496
  v_cvt_pk_bf16_f32 v80, v112, v113
  v_cvt_pk_bf16_f32 v81, v114, v115
  v_cvt_pk_bf16_f32 v82, v116, v117
  v_cvt_pk_bf16_f32 v83, v118, v119
  v_cvt_pk_bf16_f32 v84, v120, v121
  v_cvt_pk_bf16_f32 v85, v122, v123
  v_cvt_pk_bf16_f32 v86, v124, v125
  v_cvt_pk_bf16_f32 v87, v126, v127
  v_max3_f32 v90, |v112|, |v113|, |v114|
  v_max3_f32 v90, |v115|, |v116|, v90
  v_max3_f32 v90, |v117|, |v118|, v90
  v_max3_f32 v90, |v119|, |v120|, v90
  v_max3_f32 v90, |v121|, |v122|, v90
  v_max3_f32 v90, |v123|, |v124|, v90
  v_max3_f32 v90, |v125|, |v126|, v90
  v_max_f32 v90, |v127|, v90
  v_xor_b32 v92, 16, v1
  v_lshlrev_b32 v92, 2, v92
  v_xor_b32 v93, 32, v1
  v_lshlrev_b32 v93, 2, v93
  ds_bpermute_b32 v94, v92, v90
  s_waitcnt lgkmcnt(0)
  v_max_f32 v90, v90, v94
  ds_bpermute_b32 v94, v93, v90
  s_waitcnt lgkmcnt(0)
  v_max_f32 v90, v90, v94
  s_nop 1
  v_max_f32_dpp v90, v90, v90 row_ror:1 row_mask:0xf bank_mask:0xf
  s_nop 1
  v_max_f32_dpp v90, v90, v90 row_ror:2 row_mask:0xf bank_mask:0xf
  s_nop 1
  v_max_f32_dpp v90, v90, v90 row_ror:4 row_mask:0xf bank_mask:0xf
  s_nop 1
  v_max_f32_dpp v90, v90, v90 row_ror:8 row_mask:0xf bank_mask:0xf
  s_lshl_b32 s42, s22, 4
  s_lshl_b32 s44, s23, 2
  s_add_u32 s42, s42, s44
  s_sub_u32 s42, s42, 144
  v_mov_b32 v7, 0
  v_cmp_eq_u32 vcc, 0, v1
  s_and_saveexec_b64 s[44:45], vcc
  buffer_store_dword v90, v7, s[28:31], s42 offen
  s_mov_b64 exec, s[44:45]
  v_and_b32 v8, 1, v4
  v_lshrrev_b32 v9, 1, v4
  v_mul_u32_u24 v7, 304, v8
  v_lshl_add_u32 v7, v3, 4, v7
  v_lshl_add_u32 v7, v9, 3, v7
  s_cmp_eq_u32 s23, 39
  s_cbranch_scc1 L_k2_v1
  buffer_store_dwordx2 v[80:81], v7, s[24:27], s41 offen offset:1280
  buffer_store_dwordx2 v[82:83], v7, s[24:27], s41 offen offset:1888
  buffer_store_dwordx2 v[84:85], v7, s[24:27], s43 offen offset:1280
  buffer_store_dwordx2 v[86:87], v7, s[24:27], s43 offen offset:1888
  s_branch L_k2_fin
L_k2_v1:
  v_mov_b32 v10, 0x3f803f80
  v_cmp_eq_u32 vcc, 2, v3
  s_nop 1
  v_cndmask_b32 v80, v80, v10, vcc
  v_cndmask_b32 v81, v81, v10, vcc
  v_cndmask_b32 v82, v82, v10, vcc
  v_cndmask_b32 v83, v83, v10, vcc
  v_cndmask_b32 v84, v84, v10, vcc
  v_cndmask_b32 v85, v85, v10, vcc
  v_cndmask_b32 v86, v86, v10, vcc
  v_cndmask_b32 v87, v87, v10, vcc
  v_cmp_gt_u32 vcc, 3, v3
  s_and_saveexec_b64 s[44:45], vcc
  buffer_store_dwordx2 v[80:81], v7, s[24:27], s41 offen offset:1536
  buffer_store_dwordx2 v[82:83], v7, s[24:27], s41 offen offset:2144
  buffer_store_dwordx2 v[84:85], v7, s[24:27], s43 offen offset:1536
  buffer_store_dwordx2 v[86:87], v7, s[24:27], s43 offen offset:2144
L_k2_fin:
L_k2_side:
L_k2_end:
  s_endpgm
.globl attn_kernel
.p2align 8
.type attn_kernel,@function
attn_kernel:
  s_load_dwordx2 s[20:21], s[0:1], 104
  s_load_dwordx4 s[64:67], s[0:1], 48
  s_load_dwordx2 s[68:69], s[0:1], 64
  v_and_b32 v1, 63, v0
  v_lshrrev_b32 v2, 6, v0
  v_lshlrev_b32 v7, 4, v1
  v_readfirstlane_b32 s3, v2
  s_cmp_ge_u32 s2, 256
  s_cbranch_scc1 L_k3_end
  s_and_b32 s4, s3, 3
  s_lshr_b32 s5, s3, 2
  s_lshl_b32 s22, s2, 3
  s_lshl_b32 s6, s4, 1
  s_add_u32 s22, s22, s6
  s_mul_i32 s22, s22, 1152
  s_add_u32 s6, s22, 1152
  v_and_b32 v3, 31, v1
  v_lshrrev_b32 v4, 5, v1
  v_mul_u32_u24 v6, 36, v3
  v_lshl_add_u32 v5, v4, 4, v6
  s_mul_i32 s7, s5, 79872
  s_lshl_b32 s23, s4, 10
  s_add_u32 s23, s23, s7
  s_waitcnt lgkmcnt(0)
  s_add_u32 s24, s20, 1437696
  s_addc_u32 s25, s21, 0
  s_mov_b32 s26, 2359296
  s_mov_b32 s27, 0x20000
  s_add_u32 s28, s20, 3960832
  s_addc_u32 s29, s21, 0
  s_mov_b32 s30, 512
  s_mov_b32 s31, 0x20000
  s_add_u32 s32, s20, 3796992
  s_addc_u32 s33, s21, 0
  s_mov_b32 s34, 163840
  s_mov_b32 s35, 0x20000
  s_add_u32 s36, s20, 4038656
  s_addc_u32 s37, s21, 0
  s_mov_b32 s38, 2359296
  s_mov_b32 s39, 0x20000
  buffer_load_dwordx4 v[8:11], v5, s[24:27], s22 offen
  buffer_load_dword v12, v6, s[24:27], s22 offen offset:32
  buffer_load_dwordx4 v[16:19], v5, s[24:27], s6 offen
  buffer_load_dword v20, v6, s[24:27], s6 offen offset:32
  buffer_load_dwordx4 v[148:151], v7, s[28:31], 0 offen
  s_mov_b32 s49, s23
  s_mov_b32 m0, s49
  s_nop 0
  buffer_load_dwordx4 v7, s[32:35], s49 offen lds
  s_add_u32 s49, s49, 4096
  s_mov_b32 m0, s49
  s_nop 0
  buffer_load_dwordx4 v7, s[32:35], s49 offen lds
  s_add_u32 s49, s49, 4096
  s_mov_b32 m0, s49
  s_nop 0
  buffer_load_dwordx4 v7, s[32:35], s49 offen lds
  s_add_u32 s49, s49, 4096
  s_mov_b32 m0, s49
  s_nop 0
  buffer_load_dwordx4 v7, s[32:35], s49 offen lds
  s_add_u32 s49, s49, 4096
  v_add_u32 v128, s7, v7
  v_lshlrev_b32 v129, 3, v3
  v_add_u32 v129, 1024, v129
  v_add_u32 v129, s7, v129
  v_subrev_u32 v152, 20, v3
  v_subrev_u32 v153, 12, v3
  v_cmp_gt_u32 vcc, 24, v3
  s_nop 1
  v_cndmask_b32 v152, v153, v152, vcc
  v_min_u32 v152, 18, v152
  v_cmp_gt_u32 vcc, 19, v3
  s_nop 1
  v_cndmask_b32 v152, v152, v3, vcc
  v_mul_u32_u24 v130, 304, v4
  v_lshl_add_u32 v130, v152, 4, v130
  v_add_u32 v130, 1280, v130
  v_add_u32 v130, s7, v130
  v_mov_b32 v13, 0
  v_mov_b32 v14, 0
  v_mov_b32 v15, 0
  v_mov_b32 v34, 0
  v_mov_b32 v35, 0
  v_mov_b32 v96, 0
  v_mov_b32 v97, 0
  v_mov_b32 v98, 0
  v_mov_b32 v99, 0
  v_mov_b32 v100, 0
  v_mov_b32 v101, 0
  v_mov_b32 v102, 0
  v_mov_b32 v103, 0
  v_mov_b32 v104, 0
  v_mov_b32 v105, 0
  v_mov_b32 v106, 0
  v_mov_b32 v107, 0
  v_mov_b32 v108, 0
  v_mov_b32 v109, 0
  v_mov_b32 v110, 0
  v_mov_b32 v111, 0
  v_mov_b32 v21, 0
  v_mov_b32 v22, 0
  v_mov_b32 v23, 0
  v_mov_b32 v38, 0
  v_mov_b32 v39, 0
  v_mov_b32 v112, 0
  v_mov_b32 v113, 0
  v_mov_b32 v114, 0
  v_mov_b32 v115, 0
  v_mov_b32 v116, 0
  v_mov_b32 v117, 0
  v_mov_b32 v118, 0
  v_mov_b32 v119, 0
  v_mov_b32 v120, 0
  v_mov_b32 v121, 0
  v_mov_b32 v122, 0
  v_mov_b32 v123, 0
  v_mov_b32 v124, 0
  v_mov_b32 v125, 0
  v_mov_b32 v126, 0
  v_mov_b32 v127, 0
  v_mov_b32 v92, 0
  v_mov_b32 v52, 0
  v_mov_b32 v140, 0
  v_mov_b32 v93, 0
  v_mov_b32 v53, 0
  v_mov_b32 v141, 0
  v_mov_b32 v94, 0
  v_mov_b32 v54, 0
  v_mov_b32 v142, 0
  v_mov_b32 v95, 0
  v_mov_b32 v55, 0
  v_mov_b32 v143, 0
  s_cmp_lt_u32 s2, 144
  s_cselect_b32 s50, 1, 0
  s_cmp_ge_u32 s2, 72
  s_cselect_b32 s51, 1, 0
  s_cselect_b32 s8, s66, s64
  s_cselect_b32 s9, s67, s65
  s_mov_b32 s10, 5308416
  s_mov_b32 s11, 0x20000
  s_mul_i32 s77, s51, 72
  s_sub_u32 s77, s2, s77
  s_lshl_b32 s77, s77, 2
  s_add_u32 s77, s77, s4
  s_lshl_b32 s79, s77, 5
  s_lshl_b32 s78, s4, 10
  s_add_u32 s78, s78, 159744
  v_lshrrev_b32 v144, 1, v1
  s_movk_i32 s40, 9216
  v_mul_lo_u32 v144, v144, s40
  v_and_b32 v145, 1, v1
  v_lshl_add_u32 v144, v145, 4, v144
  v_lshrrev_b32 v146, 4, v1
  v_bfe_u32 v145, v1, 2, 2
  v_lshl_add_u32 v145, v146, 3, v145
  v_lshlrev_b32 v145, 5, v145
  v_and_b32 v132, 3, v1
  v_lshl_add_u32 v145, v132, 3, v145
  v_add_u32 v145, s78, v145
  v_and_b32 v132, 15, v1
  v_mul_u32_u24 v132, 1152, v132
  v_lshl_add_u32 v146, v146, 4, v132
  s_mov_b32 s41, 0
  s_mov_b32 s18, 0
  s_lshl_b32 s76, s2, 2
  s_add_u32 s76, s76, s4
  s_mul_i32 s76, s76, 5184
  s_mov_b32 s70, s76
  s_mov_b32 s72, s64
  s_mov_b32 s73, s65
  s_mov_b32 s74, 5308416
  s_mov_b32 s75, 0x20000
  s_add_u32 s44, s20, 16384
  s_addc_u32 s45, s21, 0
  s_mov_b32 s46, 2304
  s_mov_b32 s47, 0x20000
  s_mov_b32 s58, 0x7ffff
  s_mov_b32 s59, 0x7ffff
  v_mov_b32 v40, 0
  v_mov_b32 v41, 0
  v_mov_b32 v42, 0
  v_mov_b32 v43, 0
  v_mov_b32 v44, 0
  v_mov_b32 v45, 0
  v_mov_b32 v46, 0
  v_mov_b32 v47, 0
  v_mov_b32 v48, 0
  v_mov_b32 v49, 0
  v_mov_b32 v50, 0
  v_mov_b32 v51, 0
  v_mov_b32 v52, 0
  v_mov_b32 v53, 0
  v_mov_b32 v54, 0
  v_mov_b32 v55, 0
  s_waitcnt vmcnt(4)
  v_cmp_eq_u32 vcc, 0, v4
  v_xor_b32 v154, 32, v1
  v_lshlrev_b32 v154, 2, v154
  v_cndmask_b32 v12, 0, v12, vcc
  v_cndmask_b32 v20, 0, v20, vcc
  v_mov_b32 v152, 0
  v_mov_b32 v153, 0
  s_waitcnt vmcnt(0)
  s_barrier
L_k3_main:
  ds_read_b128 v[24:27], v128 offset:0
  ds_read_b64 v[32:33], v129 offset:0
  s_mov_b64 exec, s[58:59]
  ds_read_b128 v[40:43], v130 offset:0
  ds_read_b128 v[44:47], v130 offset:608
  s_mov_b64 exec, -1
  ds_read_b128 v[28:31], v128 offset:2496
  ds_read_b64 v[36:37], v129 offset:2496
  s_waitcnt lgkmcnt(4)
  v_mfma_f32_32x32x16_bf16 v[56:71], v[24:27], v[8:11], 0
  v_mfma_f32_32x32x16_bf16 v[56:71], v[32:35], v[12:15], v[56:71]
  s_nop 9
  v_dot2c_f32_bf16 v152, v8, v8
  v_dot2c_f32_bf16 v152, v9, v9
  v_dot2c_f32_bf16 v152, v10, v10
  v_dot2c_f32_bf16 v152, v11, v11
  v_dot2c_f32_bf16 v152, v12, v12
  v_dot2c_f32_bf16 v153, v16, v16
  v_dot2c_f32_bf16 v153, v17, v17
  v_dot2c_f32_bf16 v153, v18, v18
  v_dot2c_f32_bf16 v153, v19, v19
  v_dot2c_f32_bf16 v153, v20, v20
  v_max_f32 v150, v150, v151
  s_nop 2
  ds_bpermute_b32 v155, v154, v152
  ds_bpermute_b32 v156, v154, v153
  v_max_f32_dpp v148, v148, v148 row_ror:1 row_mask:0xf bank_mask:0xf
  v_max_f32_dpp v149, v149, v149 row_ror:1 row_mask:0xf bank_mask:0xf
  v_max_f32_dpp v150, v150, v150 row_ror:1 row_mask:0xf bank_mask:0xf
  v_max_f32_dpp v148, v148, v148 row_ror:2 row_mask:0xf bank_mask:0xf
  v_max_f32_dpp v149, v149, v149 row_ror:2 row_mask:0xf bank_mask:0xf
  v_max_f32_dpp v150, v150, v150 row_ror:2 row_mask:0xf bank_mask:0xf
  v_max_f32_dpp v148, v148, v148 row_ror:4 row_mask:0xf bank_mask:0xf
  v_max_f32_dpp v149, v149, v149 row_ror:4 row_mask:0xf bank_mask:0xf
  v_max_f32_dpp v150, v150, v150 row_ror:4 row_mask:0xf bank_mask:0xf
  v_max_f32_dpp v148, v148, v148 row_ror:8 row_mask:0xf bank_mask:0xf
  v_max_f32_dpp v149, v149, v149 row_ror:8 row_mask:0xf bank_mask:0xf
  v_max_f32_dpp v150, v150, v150 row_ror:8 row_mask:0xf bank_mask:0xf
  s_nop 0
  v_readlane_b32 s52, v148, 0
  v_readlane_b32 s53, v148, 16
  v_readlane_b32 s54, v149, 0
  v_readlane_b32 s55, v149, 16
  v_readlane_b32 s56, v150, 0
  v_readlane_b32 s57, v150, 16
  s_nop 3
  s_max_u32 s52, s52, s53
  s_max_u32 s54, s54, s55
  s_max_u32 s56, s56, s57
  v_mov_b32 v157, s52
  v_add_f32 v157, s54, v157
  s_waitcnt lgkmcnt(0)
  v_add_f32 v152, v152, v155
  v_add_f32 v153, v153, v156
  v_max_f32 v152, v152, v153
  v_mul_f32 v152, v152, v157
  s_mov_b32 s40, 0x45610000
  v_cmp_nge_f32 vcc, s40, v152
  s_nop 3
  s_cmp_lg_u64 vcc, 0
  s_cselect_b32 s48, 1, 0
  s_cmp_gt_u32 s56, 0x53800000
  s_cselect_b32 s48, 1, s48
  s_mov_b32 s40, 2
.p2align 6
L_k3_l1:
  v_mfma_f32_32x32x16_bf16 v[72:87], v[24:27], v[16:19], 0
  v_exp_f32 v56, v56
  v_exp_f32 v57, v57
  v_exp_f32 v58, v58
  v_exp_f32 v59, v59
  v_mfma_f32_32x32x16_bf16 v[112:127], v[52:55], v[92:95], v[112:127]
  s_mov_b64 exec, s[58:59]
  ds_read_b128 v[48:51], v130 offset:2496
  ds_read_b128 v[52:55], v130 offset:3104
  s_mov_b64 exec, -1
  v_exp_f32 v60, v60
  v_exp_f32 v61, v61
  v_exp_f32 v62, v62
  v_exp_f32 v63, v63
  s_mov_b32 m0, s49
  s_nop 0
  buffer_load_dwordx4 v7, s[32:35], s49 offen lds
  s_add_u32 s49, s49, 4096
  s_waitcnt lgkmcnt(4)
  v_cvt_pk_bf16_f32 v88, v56, v57
  v_cvt_pk_bf16_f32 v89, v58, v59
  v_cvt_pk_bf16_f32 v90, v60, v61
  v_cvt_pk_bf16_f32 v91, v62, v63
  v_mfma_f32_32x32x16_bf16 v[72:87], v[32:35], v[20:23], v[72:87]
  ds_read_b128 v[24:27], v128 offset:4992
  ds_read_b64 v[32:33], v129 offset:4992
  v_exp_f32 v64, v64
  v_exp_f32 v65, v65
  v_exp_f32 v66, v66
  v_exp_f32 v67, v67
  v_mfma_f32_32x32x16_bf16 v[96:111], v[40:43], v[88:91], v[96:111]
  v_exp_f32 v68, v68
  v_exp_f32 v69, v69
  v_exp_f32 v70, v70
  v_exp_f32 v71, v71
  s_nop 0
  v_cvt_pk_bf16_f32 v92, v64, v65
  v_cvt_pk_bf16_f32 v93, v66, v67
  v_cvt_pk_bf16_f32 v94, v68, v69
  v_cvt_pk_bf16_f32 v95, v70, v71
  s_waitcnt lgkmcnt(5)
  v_mfma_f32_32x32x16_bf16 v[56:71], v[28:31], v[8:11], 0
  v_exp_f32 v72, v72
  v_exp_f32 v73, v73
  v_exp_f32 v74, v74
  v_exp_f32 v75, v75
  v_mfma_f32_32x32x16_bf16 v[96:111], v[44:47], v[92:95], v[96:111]
  v_exp_f32 v76, v76
  v_exp_f32 v77, v77
  v_exp_f32 v78, v78
  v_exp_f32 v79, v79
  s_mov_b32 m0, s49
  s_nop 0
  buffer_load_dwordx4 v7, s[32:35], s49 offen lds
  s_add_u32 s49, s49, 4096
  s_waitcnt lgkmcnt(4)
  v_cvt_pk_bf16_f32 v88, v72, v73
  v_cvt_pk_bf16_f32 v89, v74, v75
  v_cvt_pk_bf16_f32 v90, v76, v77
  v_cvt_pk_bf16_f32 v91, v78, v79
  v_mfma_f32_32x32x16_bf16 v[56:71], v[36:39], v[12:15], v[56:71]
  v_exp_f32 v80, v80
  v_exp_f32 v81, v81
  v_exp_f32 v82, v82
  v_exp_f32 v83, v83
  v_mfma_f32_32x32x16_bf16 v[112:127], v[40:43], v[88:91], v[112:127]
  v_exp_f32 v84, v84
  v_exp_f32 v85, v85
  v_exp_f32 v86, v86
  v_exp_f32 v87, v87
  s_nop 0
  v_cvt_pk_bf16_f32 v92, v80, v81
  v_cvt_pk_bf16_f32 v93, v82, v83
  v_cvt_pk_bf16_f32 v94, v84, v85
  v_cvt_pk_bf16_f32 v95, v86, v87
  v_mfma_f32_32x32x16_bf16 v[72:87], v[28:31], v[16:19], 0
  v_exp_f32 v56, v56
  v_exp_f32 v57, v57
  v_exp_f32 v58, v58
  v_exp_f32 v59, v59
  v_mfma_f32_32x32x16_bf16 v[112:127], v[44:47], v[92:95], v[112:127]
  s_mov_b64 exec, s[58:59]
  ds_read_b128 v[40:43], v130 offset:4992
  ds_read_b128 v[44:47], v130 offset:5600
  s_mov_b64 exec, -1
  v_exp_f32 v60, v60
  v_exp_f32 v61, v61
  v_exp_f32 v62, v62
  v_exp_f32 v63, v63
  s_mov_b32 m0, s49
  s_nop 0
  buffer_load_dwordx4 v7, s[32:35], s49 offen lds
  s_add_u32 s49, s49, 4096
  s_waitcnt lgkmcnt(4)
  v_cvt_pk_bf16_f32 v88, v56, v57
  v_cvt_pk_bf16_f32 v89, v58, v59
  v_cvt_pk_bf16_f32 v90, v60, v61
  v_cvt_pk_bf16_f32 v91, v62, v63
  v_mfma_f32_32x32x16_bf16 v[72:87], v[36:39], v[20:23], v[72:87]
  ds_read_b128 v[28:31], v128 offset:7488
  ds_read_b64 v[36:37], v129 offset:7488
  v_exp_f32 v64, v64
  v_exp_f32 v65, v65
  v_exp_f32 v66, v66
  v_exp_f32 v67, v67
  v_mfma_f32_32x32x16_bf16 v[96:111], v[48:51], v[88:91], v[96:111]
  v_exp_f32 v68, v68
  v_exp_f32 v69, v69
  v_exp_f32 v70, v70
  v_exp_f32 v71, v71
  s_nop 0
  v_cvt_pk_bf16_f32 v92, v64, v65
  v_cvt_pk_bf16_f32 v93, v66, v67
  v_cvt_pk_bf16_f32 v94, v68, v69
  v_cvt_pk_bf16_f32 v95, v70, v71
  s_waitcnt lgkmcnt(5)
  v_mfma_f32_32x32x16_bf16 v[56:71], v[24:27], v[8:11], 0
  v_exp_f32 v72, v72
  v_exp_f32 v73, v73
  v_exp_f32 v74, v74
  v_exp_f32 v75, v75
  v_mfma_f32_32x32x16_bf16 v[96:111], v[52:55], v[92:95], v[96:111]
  v_exp_f32 v76, v76
  v_exp_f32 v77, v77
  v_exp_f32 v78, v78
  v_exp_f32 v79, v79
  s_mov_b32 m0, s49
  s_nop 0
  buffer_load_dwordx4 v7, s[32:35], s49 offen lds
  s_add_u32 s49, s49, 4096
  s_waitcnt lgkmcnt(4)
  v_cvt_pk_bf16_f32 v88, v72, v73
  v_cvt_pk_bf16_f32 v89, v74, v75
  v_cvt_pk_bf16_f32 v90, v76, v77
  v_cvt_pk_bf16_f32 v91, v78, v79
  v_mfma_f32_32x32x16_bf16 v[56:71], v[32:35], v[12:15], v[56:71]
  v_exp_f32 v80, v80
  v_exp_f32 v81, v81
  v_exp_f32 v82, v82
  v_exp_f32 v83, v83
  v_mfma_f32_32x32x16_bf16 v[112:127], v[48:51], v[88:91], v[112:127]
  v_exp_f32 v84, v84
  v_exp_f32 v85, v85
  v_exp_f32 v86, v86
  v_exp_f32 v87, v87
  v_add_u32 v128, 4992, v128
  v_add_u32 v129, 4992, v129
  v_add_u32 v130, 4992, v130
  s_sub_u32 s40, s40, 1
  s_cmp_lg_u32 s40, 0
  v_cvt_pk_bf16_f32 v92, v80, v81
  v_cvt_pk_bf16_f32 v93, v82, v83
  v_cvt_pk_bf16_f32 v94, v84, v85
  v_cvt_pk_bf16_f32 v95, v86, v87
  s_cbranch_scc1 L_k3_l1
  s_waitcnt vmcnt(4)
  s_barrier
  s_mov_b32 s40, 2
.p2align 6
L_k3_l2:
  v_mfma_f32_32x32x16_bf16 v[72:87], v[24:27], v[16:19], 0
  v_exp_f32 v56, v56
  v_exp_f32 v57, v57
  v_exp_f32 v58, v58
  v_exp_f32 v59, v59
  v_mfma_f32_32x32x16_bf16 v[112:127], v[52:55], v[92:95], v[112:127]
  s_mov_b64 exec, s[58:59]
  ds_read_b128 v[48:51], v130 offset:2496
  ds_read_b128 v[52:55], v130 offset:3104
  s_mov_b64 exec, -1
  v_exp_f32 v60, v60
  v_exp_f32 v61, v61
  v_exp_f32 v62, v62
  v_exp_f32 v63, v63
  s_mov_b32 m0, s49
  s_nop 0
  buffer_load_dwordx4 v7, s[32:35], s49 offen lds
  s_add_u32 s49, s49, 4096
  s_waitcnt lgkmcnt(4)
  v_cvt_pk_bf16_f32 v88, v56, v57
  v_cvt_pk_bf16_f32 v89, v58, v59
  v_cvt_pk_bf16_f32 v90, v60, v61
  v_cvt_pk_bf16_f32 v91, v62, v63
  v_mfma_f32_32x32x16_bf16 v[72:87], v[32:35], v[20:23], v[72:87]
  ds_read_b128 v[24:27], v128 offset:4992
  ds_read_b64 v[32:33], v129 offset:4992
  v_exp_f32 v64, v64
  v_exp_f32 v65, v65
  v_exp_f32 v66, v66
  v_exp_f32 v67, v67
  v_mfma_f32_32x32x16_bf16 v[96:111], v[40:43], v[88:91], v[96:111]
  v_exp_f32 v68, v68
  v_exp_f32 v69, v69
  v_exp_f32 v70, v70
  v_exp_f32 v71, v71
  s_nop 0
  v_cvt_pk_bf16_f32 v92, v64, v65
  v_cvt_pk_bf16_f32 v93, v66, v67
  v_cvt_pk_bf16_f32 v94, v68, v69
  v_cvt_pk_bf16_f32 v95, v70, v71
  s_waitcnt lgkmcnt(5)
  v_mfma_f32_32x32x16_bf16 v[56:71], v[28:31], v[8:11], 0
  v_exp_f32 v72, v72
  v_exp_f32 v73, v73
  v_exp_f32 v74, v74
  v_exp_f32 v75, v75
  v_mfma_f32_32x32x16_bf16 v[96:111], v[44:47], v[92:95], v[96:111]
  v_exp_f32 v76, v76
  v_exp_f32 v77, v77
  v_exp_f32 v78, v78
  v_exp_f32 v79, v79
  s_mov_b32 m0, s49
  s_nop 0
  buffer_load_dwordx4 v7, s[32:35], s49 offen lds
  s_add_u32 s49, s49, 4096
  s_waitcnt lgkmcnt(4)
  v_cvt_pk_bf16_f32 v88, v72, v73
  v_cvt_pk_bf16_f32 v89, v74, v75
  v_cvt_pk_bf16_f32 v90, v76, v77
  v_cvt_pk_bf16_f32 v91, v78, v79
  v_mfma_f32_32x32x16_bf16 v[56:71], v[36:39], v[12:15], v[56:71]
  v_exp_f32 v80, v80
  v_exp_f32 v81, v81
  v_exp_f32 v82, v82
  v_exp_f32 v83, v83
  v_mfma_f32_32x32x16_bf16 v[112:127], v[40:43], v[88:91], v[112:127]
  v_exp_f32 v84, v84
  v_exp_f32 v85, v85
  v_exp_f32 v86, v86
  v_exp_f32 v87, v87
  s_nop 0
  v_cvt_pk_bf16_f32 v92, v80, v81
  v_cvt_pk_bf16_f32 v93, v82, v83
  v_cvt_pk_bf16_f32 v94, v84, v85
  v_cvt_pk_bf16_f32 v95, v86, v87
  v_mfma_f32_32x32x16_bf16 v[72:87], v[28:31], v[16:19], 0
  v_exp_f32 v56, v56
  v_exp_f32 v57, v57
  v_exp_f32 v58, v58
  v_exp_f32 v59, v59
  v_mfma_f32_32x32x16_bf16 v[112:127], v[44:47], v[92:95], v[112:127]
  s_mov_b64 exec, s[58:59]
  ds_read_b128 v[40:43], v130 offset:4992
  ds_read_b128 v[44:47], v130 offset:5600
  s_mov_b64 exec, -1
  v_exp_f32 v60, v60
  v_exp_f32 v61, v61
  v_exp_f32 v62, v62
  v_exp_f32 v63, v63
  s_mov_b32 m0, s49
  s_nop 0
  buffer_load_dwordx4 v7, s[32:35], s49 offen lds
  s_add_u32 s49, s49, 4096
  s_waitcnt lgkmcnt(4)
  v_cvt_pk_bf16_f32 v88, v56, v57
  v_cvt_pk_bf16_f32 v89, v58, v59
  v_cvt_pk_bf16_f32 v90, v60, v61
  v_cvt_pk_bf16_f32 v91, v62, v63
  v_mfma_f32_32x32x16_bf16 v[72:87], v[36:39], v[20:23], v[72:87]
  ds_read_b128 v[28:31], v128 offset:7488
  ds_read_b64 v[36:37], v129 offset:7488
  v_exp_f32 v64, v64
  v_exp_f32 v65, v65
  v_exp_f32 v66, v66
  v_exp_f32 v67, v67
  v_mfma_f32_32x32x16_bf16 v[96:111], v[48:51], v[88:91], v[96:111]
  v_exp_f32 v68, v68
  v_exp_f32 v69, v69
  v_exp_f32 v70, v70
  v_exp_f32 v71, v71
  s_nop 0
  v_cvt_pk_bf16_f32 v92, v64, v65
  v_cvt_pk_bf16_f32 v93, v66, v67
  v_cvt_pk_bf16_f32 v94, v68, v69
  v_cvt_pk_bf16_f32 v95, v70, v71
  s_waitcnt lgkmcnt(5)
  v_mfma_f32_32x32x16_bf16 v[56:71], v[24:27], v[8:11], 0
  v_exp_f32 v72, v72
  v_exp_f32 v73, v73
  v_exp_f32 v74, v74
  v_exp_f32 v75, v75
  v_mfma_f32_32x32x16_bf16 v[96:111], v[52:55], v[92:95], v[96:111]
  v_exp_f32 v76, v76
  v_exp_f32 v77, v77
  v_exp_f32 v78, v78
  v_exp_f32 v79, v79
  s_mov_b32 m0, s49
  s_nop 0
  buffer_load_dwordx4 v7, s[32:35], s49 offen lds
  s_add_u32 s49, s49, 4096
  s_waitcnt lgkmcnt(4)
  v_cvt_pk_bf16_f32 v88, v72, v73
  v_cvt_pk_bf16_f32 v89, v74, v75
  v_cvt_pk_bf16_f32 v90, v76, v77
  v_cvt_pk_bf16_f32 v91, v78, v79
  v_mfma_f32_32x32x16_bf16 v[56:71], v[32:35], v[12:15], v[56:71]
  v_exp_f32 v80, v80
  v_exp_f32 v81, v81
  v_exp_f32 v82, v82
  v_exp_f32 v83, v83
  v_mfma_f32_32x32x16_bf16 v[112:127], v[48:51], v[88:91], v[112:127]
  v_exp_f32 v84, v84
  v_exp_f32 v85, v85
  v_exp_f32 v86, v86
  v_exp_f32 v87, v87
  v_add_u32 v128, 4992, v128
  v_add_u32 v129, 4992, v129
  v_add_u32 v130, 4992, v130
  s_sub_u32 s40, s40, 1
  s_cmp_lg_u32 s40, 0
  v_cvt_pk_bf16_f32 v92, v80, v81
  v_cvt_pk_bf16_f32 v93, v82, v83
  v_cvt_pk_bf16_f32 v94, v84, v85
  v_cvt_pk_bf16_f32 v95, v86, v87
  s_cbranch_scc1 L_k3_l2
  s_mov_b32 s40, 1
  s_mov_b32 s43, 2
  s_branch L_k3_plain
L_k3_b2:
  s_waitcnt vmcnt(0)
  s_barrier
  s_mov_b32 s43, 0
  s_cmp_ge_u32 s3, 4
  s_cbranch_scc1 L_k3_w
  s_mov_b32 s40, 11
  s_cmp_eq_u32 s50, 0
  s_cbranch_scc1 L_k3_plain
  s_mov_b32 s40, 1
  s_mov_b32 s43, 1
  s_branch L_k3_plain
L_k3_w:
  s_mov_b32 s71, 10
  s_mov_b32 s40, 5
.p2align 6
L_k3_lw:
  v_mfma_f32_32x32x16_bf16 v[72:87], v[24:27], v[16:19], 0
  v_exp_f32 v56, v56
  v_exp_f32 v57, v57
  v_exp_f32 v58, v58
  v_exp_f32 v59, v59
  v_mfma_f32_32x32x16_bf16 v[112:127], v[52:55], v[92:95], v[112:127]
  s_mov_b64 exec, s[58:59]
  ds_read_b128 v[48:51], v130 offset:2496
  ds_read_b128 v[52:55], v130 offset:3104
  s_mov_b64 exec, -1
  v_exp_f32 v60, v60
  v_exp_f32 v61, v61
  v_exp_f32 v62, v62
  v_exp_f32 v63, v63
  buffer_load_dwordx4 v[148:151], v7, s[72:75], s76 offen offset:0
  s_waitcnt lgkmcnt(4)
  v_cvt_pk_bf16_f32 v88, v56, v57
  v_cvt_pk_bf16_f32 v89, v58, v59
  v_cvt_pk_bf16_f32 v90, v60, v61
  v_cvt_pk_bf16_f32 v91, v62, v63
  v_mfma_f32_32x32x16_bf16 v[72:87], v[32:35], v[20:23], v[72:87]
  ds_read_b128 v[24:27], v128 offset:4992
  ds_read_b64 v[32:33], v129 offset:4992
  v_exp_f32 v64, v64
  v_exp_f32 v65, v65
  v_exp_f32 v66, v66
  v_exp_f32 v67, v67
  v_mfma_f32_32x32x16_bf16 v[96:111], v[40:43], v[88:91], v[96:111]
  v_exp_f32 v68, v68
  v_exp_f32 v69, v69
  v_exp_f32 v70, v70
  v_exp_f32 v71, v71
  s_nop 0
  v_cvt_pk_bf16_f32 v92, v64, v65
  v_cvt_pk_bf16_f32 v93, v66, v67
  v_cvt_pk_bf16_f32 v94, v68, v69
  v_cvt_pk_bf16_f32 v95, v70, v71
  s_waitcnt lgkmcnt(5)
  v_mfma_f32_32x32x16_bf16 v[56:71], v[28:31], v[8:11], 0
  v_exp_f32 v72, v72
  v_exp_f32 v73, v73
  v_exp_f32 v74, v74
  v_exp_f32 v75, v75
  v_mfma_f32_32x32x16_bf16 v[96:111], v[44:47], v[92:95], v[96:111]
  v_exp_f32 v76, v76
  v_exp_f32 v77, v77
  v_exp_f32 v78, v78
  v_exp_f32 v79, v79
  buffer_load_dwordx4 v[152:155], v7, s[72:75], s76 offen offset:1024
  s_add_u32 s76, s76, 2048
  s_sub_u32 s71, s71, 1
  s_cmp_eq_u32 s71, 7
  s_cselect_b32 s72, s66, s72
  s_cselect_b32 s73, s67, s73
  s_cselect_b32 s76, s70, s76
  s_cmp_eq_u32 s71, 4
  s_cselect_b32 s72, s68, s72
  s_cselect_b32 s73, s69, s73
  s_cselect_b32 s76, s70, s76
  s_waitcnt lgkmcnt(4)
  v_cvt_pk_bf16_f32 v88, v72, v73
  v_cvt_pk_bf16_f32 v89, v74, v75
  v_cvt_pk_bf16_f32 v90, v76, v77
  v_cvt_pk_bf16_f32 v91, v78, v79
  v_mfma_f32_32x32x16_bf16 v[56:71], v[36:39], v[12:15], v[56:71]
  v_exp_f32 v80, v80
  v_exp_f32 v81, v81
  v_exp_f32 v82, v82
  v_exp_f32 v83, v83
  v_mfma_f32_32x32x16_bf16 v[112:127], v[40:43], v[88:91], v[112:127]
  v_exp_f32 v84, v84
  v_exp_f32 v85, v85
  v_exp_f32 v86, v86
  v_exp_f32 v87, v87
  s_nop 0
  v_cvt_pk_bf16_f32 v92, v80, v81
  v_cvt_pk_bf16_f32 v93, v82, v83
  v_cvt_pk_bf16_f32 v94, v84, v85
  v_cvt_pk_bf16_f32 v95, v86, v87
  v_mfma_f32_32x32x16_bf16 v[72:87], v[28:31], v[16:19], 0
  v_exp_f32 v56, v56
  v_exp_f32 v57, v57
  v_exp_f32 v58, v58
  v_exp_f32 v59, v59
  v_mfma_f32_32x32x16_bf16 v[112:127], v[44:47], v[92:95], v[112:127]
  s_mov_b64 exec, s[58:59]
  ds_read_b128 v[40:43], v130 offset:4992
  ds_read_b128 v[44:47], v130 offset:5600
  s_mov_b64 exec, -1
  v_exp_f32 v60, v60
  v_exp_f32 v61, v61
  v_exp_f32 v62, v62
  v_exp_f32 v63, v63
  buffer_load_dwordx4 v[156:159], v7, s[72:75], s76 offen offset:0
  s_waitcnt lgkmcnt(4)
  v_cvt_pk_bf16_f32 v88, v56, v57
  v_cvt_pk_bf16_f32 v89, v58, v59
  v_cvt_pk_bf16_f32 v90, v60, v61
  v_cvt_pk_bf16_f32 v91, v62, v63
  v_mfma_f32_32x32x16_bf16 v[72:87], v[36:39], v[20:23], v[72:87]
  ds_read_b128 v[28:31], v128 offset:7488
  ds_read_b64 v[36:37], v129 offset:7488
  v_exp_f32 v64, v64
  v_exp_f32 v65, v65
  v_exp_f32 v66, v66
  v_exp_f32 v67, v67
  v_mfma_f32_32x32x16_bf16 v[96:111], v[48:51], v[88:91], v[96:111]
  v_exp_f32 v68, v68
  v_exp_f32 v69, v69
  v_exp_f32 v70, v70
  v_exp_f32 v71, v71
  s_nop 0
  v_cvt_pk_bf16_f32 v92, v64, v65
  v_cvt_pk_bf16_f32 v93, v66, v67
  v_cvt_pk_bf16_f32 v94, v68, v69
  v_cvt_pk_bf16_f32 v95, v70, v71
  s_waitcnt lgkmcnt(5)
  v_mfma_f32_32x32x16_bf16 v[56:71], v[24:27], v[8:11], 0
  v_exp_f32 v72, v72
  v_exp_f32 v73, v73
  v_exp_f32 v74, v74
  v_exp_f32 v75, v75
  v_mfma_f32_32x32x16_bf16 v[96:111], v[52:55], v[92:95], v[96:111]
  v_exp_f32 v76, v76
  v_exp_f32 v77, v77
  v_exp_f32 v78, v78
  v_exp_f32 v79, v79
  buffer_load_dwordx4 v[160:163], v7, s[72:75], s76 offen offset:1024
  s_add_u32 s76, s76, 2048
  s_sub_u32 s71, s71, 1
  s_cmp_eq_u32 s71, 7
  s_cselect_b32 s72, s66, s72
  s_cselect_b32 s73, s67, s73
  s_cselect_b32 s76, s70, s76
  s_cmp_eq_u32 s71, 4
  s_cselect_b32 s72, s68, s72
  s_cselect_b32 s73, s69, s73
  s_cselect_b32 s76, s70, s76
  s_waitcnt lgkmcnt(4)
  v_cvt_pk_bf16_f32 v88, v72, v73
  v_cvt_pk_bf16_f32 v89, v74, v75
  v_cvt_pk_bf16_f32 v90, v76, v77
  v_cvt_pk_bf16_f32 v91, v78, v79
  v_mfma_f32_32x32x16_bf16 v[56:71], v[32:35], v[12:15], v[56:71]
  v_exp_f32 v80, v80
  v_exp_f32 v81, v81
  v_exp_f32 v82, v82
  v_exp_f32 v83, v83
  v_mfma_f32_32x32x16_bf16 v[112:127], v[48:51], v[88:91], v[112:127]
  v_exp_f32 v84, v84
  v_exp_f32 v85, v85
  v_exp_f32 v86, v86
  v_exp_f32 v87, v87
  v_add_u32 v128, 4992, v128
  v_add_u32 v129, 4992, v129
  v_add_u32 v130, 4992, v130
  s_sub_u32 s40, s40, 1
  s_cmp_lg_u32 s40, 0
  v_cvt_pk_bf16_f32 v92, v80, v81
  v_cvt_pk_bf16_f32 v93, v82, v83
  v_cvt_pk_bf16_f32 v94, v84, v85
  v_cvt_pk_bf16_f32 v95, v86, v87
  s_cbranch_scc1 L_k3_lw
  s_mov_b32 s40, 6
L_k3_plain:
.p2align 6
L_k3_lp:
  v_mfma_f32_32x32x16_bf16 v[72:87], v[24:27], v[16:19], 0
  v_exp_f32 v56, v56
  v_exp_f32 v57, v57
  v_exp_f32 v58, v58
  v_exp_f32 v59, v59
  v_mfma_f32_32x32x16_bf16 v[112:127], v[52:55], v[92:95], v[112:127]
  s_mov_b64 exec, s[58:59]
  ds_read_b128 v[48:51], v130 offset:2496
  ds_read_b128 v[52:55], v130 offset:3104
  s_mov_b64 exec, -1
  v_exp_f32 v60, v60
  v_exp_f32 v61, v61
  v_exp_f32 v62, v62
  v_exp_f32 v63, v63
  s_waitcnt lgkmcnt(4)
  v_cvt_pk_bf16_f32 v88, v56, v57
  v_cvt_pk_bf16_f32 v89, v58, v59
  v_cvt_pk_bf16_f32 v90, v60, v61
  v_cvt_pk_bf16_f32 v91, v62, v63
  v_mfma_f32_32x32x16_bf16 v[72:87], v[32:35], v[20:23], v[72:87]
  ds_read_b128 v[24:27], v128 offset:4992
  ds_read_b64 v[32:33], v129 offset:4992
  v_exp_f32 v64, v64
  v_exp_f32 v65, v65
  v_exp_f32 v66, v66
  v_exp_f32 v67, v67
  v_mfma_f32_32x32x16_bf16 v[96:111], v[40:43], v[88:91], v[96:111]
  v_exp_f32 v68, v68
  v_exp_f32 v69, v69
  v_exp_f32 v70, v70
  v_exp_f32 v71, v71
  s_nop 0
  v_cvt_pk_bf16_f32 v92, v64, v65
  v_cvt_pk_bf16_f32 v93, v66, v67
  v_cvt_pk_bf16_f32 v94, v68, v69
  v_cvt_pk_bf16_f32 v95, v70, v71
  s_waitcnt lgkmcnt(5)
  v_mfma_f32_32x32x16_bf16 v[56:71], v[28:31], v[8:11], 0
  v_exp_f32 v72, v72
  v_exp_f32 v73, v73
  v_exp_f32 v74, v74
  v_exp_f32 v75, v75
  v_mfma_f32_32x32x16_bf16 v[96:111], v[44:47], v[92:95], v[96:111]
  v_exp_f32 v76, v76
  v_exp_f32 v77, v77
  v_exp_f32 v78, v78
  v_exp_f32 v79, v79
  s_waitcnt lgkmcnt(4)
  v_cvt_pk_bf16_f32 v88, v72, v73
  v_cvt_pk_bf16_f32 v89, v74, v75
  v_cvt_pk_bf16_f32 v90, v76, v77
  v_cvt_pk_bf16_f32 v91, v78, v79
  v_mfma_f32_32x32x16_bf16 v[56:71], v[36:39], v[12:15], v[56:71]
  v_exp_f32 v80, v80
  v_exp_f32 v81, v81
  v_exp_f32 v82, v82
  v_exp_f32 v83, v83
  v_mfma_f32_32x32x16_bf16 v[112:127], v[40:43], v[88:91], v[112:127]
  v_exp_f32 v84, v84
  v_exp_f32 v85, v85
  v_exp_f32 v86, v86
  v_exp_f32 v87, v87
  s_nop 0
  v_cvt_pk_bf16_f32 v92, v80, v81
  v_cvt_pk_bf16_f32 v93, v82, v83
  v_cvt_pk_bf16_f32 v94, v84, v85
  v_cvt_pk_bf16_f32 v95, v86, v87
  v_mfma_f32_32x32x16_bf16 v[72:87], v[28:31], v[16:19], 0
  v_exp_f32 v56, v56
  v_exp_f32 v57, v57
  v_exp_f32 v58, v58
  v_exp_f32 v59, v59
  v_mfma_f32_32x32x16_bf16 v[112:127], v[44:47], v[92:95], v[112:127]
  s_mov_b64 exec, s[58:59]
  ds_read_b128 v[40:43], v130 offset:4992
  ds_read_b128 v[44:47], v130 offset:5600
  s_mov_b64 exec, -1
  v_exp_f32 v60, v60
  v_exp_f32 v61, v61
  v_exp_f32 v62, v62
  v_exp_f32 v63, v63
  s_waitcnt lgkmcnt(4)
  v_cvt_pk_bf16_f32 v88, v56, v57
  v_cvt_pk_bf16_f32 v89, v58, v59
  v_cvt_pk_bf16_f32 v90, v60, v61
  v_cvt_pk_bf16_f32 v91, v62, v63
  v_mfma_f32_32x32x16_bf16 v[72:87], v[36:39], v[20:23], v[72:87]
  ds_read_b128 v[28:31], v128 offset:7488
  ds_read_b64 v[36:37], v129 offset:7488
  v_exp_f32 v64, v64
  v_exp_f32 v65, v65
  v_exp_f32 v66, v66
  v_exp_f32 v67, v67
  v_mfma_f32_32x32x16_bf16 v[96:111], v[48:51], v[88:91], v[96:111]
  v_exp_f32 v68, v68
  v_exp_f32 v69, v69
  v_exp_f32 v70, v70
  v_exp_f32 v71, v71
  s_nop 0
  v_cvt_pk_bf16_f32 v92, v64, v65
  v_cvt_pk_bf16_f32 v93, v66, v67
  v_cvt_pk_bf16_f32 v94, v68, v69
  v_cvt_pk_bf16_f32 v95, v70, v71
  s_waitcnt lgkmcnt(5)
  v_mfma_f32_32x32x16_bf16 v[56:71], v[24:27], v[8:11], 0
  v_exp_f32 v72, v72
  v_exp_f32 v73, v73
  v_exp_f32 v74, v74
  v_exp_f32 v75, v75
  v_mfma_f32_32x32x16_bf16 v[96:111], v[52:55], v[92:95], v[96:111]
  v_exp_f32 v76, v76
  v_exp_f32 v77, v77
  v_exp_f32 v78, v78
  v_exp_f32 v79, v79
  s_waitcnt lgkmcnt(4)
  v_cvt_pk_bf16_f32 v88, v72, v73
  v_cvt_pk_bf16_f32 v89, v74, v75
  v_cvt_pk_bf16_f32 v90, v76, v77
  v_cvt_pk_bf16_f32 v91, v78, v79
  v_mfma_f32_32x32x16_bf16 v[56:71], v[32:35], v[12:15], v[56:71]
  v_exp_f32 v80, v80
  v_exp_f32 v81, v81
  v_exp_f32 v82, v82
  v_exp_f32 v83, v83
  v_mfma_f32_32x32x16_bf16 v[112:127], v[48:51], v[88:91], v[112:127]
  v_exp_f32 v84, v84
  v_exp_f32 v85, v85
  v_exp_f32 v86, v86
  v_exp_f32 v87, v87
  v_add_u32 v128, 4992, v128
  v_add_u32 v129, 4992, v129
  v_add_u32 v130, 4992, v130
  s_sub_u32 s40, s40, 1
  s_cmp_lg_u32 s40, 0
  v_cvt_pk_bf16_f32 v92, v80, v81
  v_cvt_pk_bf16_f32 v93, v82, v83
  v_cvt_pk_bf16_f32 v94, v84, v85
  v_cvt_pk_bf16_f32 v95, v86, v87
  s_cbranch_scc1 L_k3_lp
  s_cmp_eq_u32 s43, 0
  s_cbranch_scc1 L_k3_done
  s_cmp_eq_u32 s43, 2
  s_cbranch_scc1 L_k3_b2
  s_cmp_eq_u32 s43, 3
  s_cbranch_scc1 L_k3_ls1
  s_mov_b32 m0, s78
  s_nop 0
  buffer_load_dwordx4 v144, s[8:11], s79 offen lds
  buffer_load_dwordx4 v[132:135], v146, s[44:47], s41 offen
  s_add_u32 s79, s79, 294912
  s_add_u32 s41, s41, 64
  s_mov_b32 s43, 3
  s_mov_b32 s40, 1
  s_branch L_k3_plain
L_k3_ls1:
  s_mov_b32 s40, 9
.p2align 6
L_k3_ls:
  v_mfma_f32_32x32x16_bf16 v[72:87], v[24:27], v[16:19], 0
  v_exp_f32 v56, v56
  v_exp_f32 v57, v57
  v_exp_f32 v58, v58
  v_exp_f32 v59, v59
  v_mfma_f32_32x32x16_bf16 v[112:127], v[52:55], v[92:95], v[112:127]
  s_mov_b64 exec, s[58:59]
  ds_read_b128 v[48:51], v130 offset:2496
  ds_read_b128 v[52:55], v130 offset:3104
  s_mov_b64 exec, -1
  v_exp_f32 v60, v60
  v_exp_f32 v61, v61
  v_exp_f32 v62, v62
  v_exp_f32 v63, v63
  s_waitcnt vmcnt(0)
  ds_read_b64_tr_b16 v[136:137], v145
  ds_read_b64_tr_b16 v[138:139], v145 offset:128
  s_waitcnt lgkmcnt(4)
  v_cvt_pk_bf16_f32 v88, v56, v57
  v_cvt_pk_bf16_f32 v89, v58, v59
  v_cvt_pk_bf16_f32 v90, v60, v61
  v_cvt_pk_bf16_f32 v91, v62, v63
  v_mfma_f32_32x32x16_bf16 v[72:87], v[32:35], v[20:23], v[72:87]
  ds_read_b128 v[24:27], v128 offset:4992
  ds_read_b64 v[32:33], v129 offset:4992
  v_exp_f32 v64, v64
  v_exp_f32 v65, v65
  v_exp_f32 v66, v66
  v_exp_f32 v67, v67
  v_mfma_f32_32x32x16_bf16 v[96:111], v[40:43], v[88:91], v[96:111]
  s_waitcnt lgkmcnt(0)
  v_mfma_f32_16x16x32_bf16 v[140:143], v[136:139], v[132:135], v[140:143]
  s_mov_b32 m0, s78
  s_nop 0
  buffer_load_dwordx4 v144, s[8:11], s79 offen lds
  buffer_load_dwordx4 v[132:135], v146, s[44:47], s41 offen
  s_add_u32 s79, s79, 294912
  s_add_u32 s41, s41, 64
  v_exp_f32 v68, v68
  v_exp_f32 v69, v69
  v_exp_f32 v70, v70
  v_exp_f32 v71, v71
  s_nop 0
  v_cvt_pk_bf16_f32 v92, v64, v65
  v_cvt_pk_bf16_f32 v93, v66, v67
  v_cvt_pk_bf16_f32 v94, v68, v69
  v_cvt_pk_bf16_f32 v95, v70, v71
  s_waitcnt lgkmcnt(5)
  v_mfma_f32_32x32x16_bf16 v[56:71], v[28:31], v[8:11], 0
  v_exp_f32 v72, v72
  v_exp_f32 v73, v73
  v_exp_f32 v74, v74
  v_exp_f32 v75, v75
  v_mfma_f32_32x32x16_bf16 v[96:111], v[44:47], v[92:95], v[96:111]
  v_exp_f32 v76, v76
  v_exp_f32 v77, v77
  v_exp_f32 v78, v78
  v_exp_f32 v79, v79
  s_waitcnt lgkmcnt(4)
  v_cvt_pk_bf16_f32 v88, v72, v73
  v_cvt_pk_bf16_f32 v89, v74, v75
  v_cvt_pk_bf16_f32 v90, v76, v77
  v_cvt_pk_bf16_f32 v91, v78, v79
  v_mfma_f32_32x32x16_bf16 v[56:71], v[36:39], v[12:15], v[56:71]
  v_exp_f32 v80, v80
  v_exp_f32 v81, v81
  v_exp_f32 v82, v82
  v_exp_f32 v83, v83
  v_mfma_f32_32x32x16_bf16 v[112:127], v[40:43], v[88:91], v[112:127]
  v_exp_f32 v84, v84
  v_exp_f32 v85, v85
  v_exp_f32 v86, v86
  v_exp_f32 v87, v87
  s_nop 0
  v_cvt_pk_bf16_f32 v92, v80, v81
  v_cvt_pk_bf16_f32 v93, v82, v83
  v_cvt_pk_bf16_f32 v94, v84, v85
  v_cvt_pk_bf16_f32 v95, v86, v87
  v_mfma_f32_32x32x16_bf16 v[72:87], v[28:31], v[16:19], 0
  v_exp_f32 v56, v56
  v_exp_f32 v57, v57
  v_exp_f32 v58, v58
  v_exp_f32 v59, v59
  v_mfma_f32_32x32x16_bf16 v[112:127], v[44:47], v[92:95], v[112:127]
  s_mov_b64 exec, s[58:59]
  ds_read_b128 v[40:43], v130 offset:4992
  ds_read_b128 v[44:47], v130 offset:5600
  s_mov_b64 exec, -1
  v_exp_f32 v60, v60
  v_exp_f32 v61, v61
  v_exp_f32 v62, v62
  v_exp_f32 v63, v63
  s_waitcnt vmcnt(0)
  ds_read_b64_tr_b16 v[136:137], v145
  ds_read_b64_tr_b16 v[138:139], v145 offset:128
  s_waitcnt lgkmcnt(4)
  v_cvt_pk_bf16_f32 v88, v56, v57
  v_cvt_pk_bf16_f32 v89, v58, v59
  v_cvt_pk_bf16_f32 v90, v60, v61
  v_cvt_pk_bf16_f32 v91, v62, v63
  v_mfma_f32_32x32x16_bf16 v[72:87], v[36:39], v[20:23], v[72:87]
  ds_read_b128 v[28:31], v128 offset:7488
  ds_read_b64 v[36:37], v129 offset:7488
  v_exp_f32 v64, v64
  v_exp_f32 v65, v65
  v_exp_f32 v66, v66
  v_exp_f32 v67, v67
  v_mfma_f32_32x32x16_bf16 v[96:111], v[48:51], v[88:91], v[96:111]
  s_waitcnt lgkmcnt(0)
  v_mfma_f32_16x16x32_bf16 v[140:143], v[136:139], v[132:135], v[140:143]
  s_mov_b32 m0, s78
  s_nop 0
  buffer_load_dwordx4 v144, s[8:11], s79 offen lds
  buffer_load_dwordx4 v[132:135], v146, s[44:47], s41 offen
  s_add_u32 s79, s79, 294912
  s_add_u32 s41, s41, 64
  v_exp_f32 v68, v68
  v_exp_f32 v69, v69
  v_exp_f32 v70, v70
  v_exp_f32 v71, v71
  s_nop 0
  v_cvt_pk_bf16_f32 v92, v64, v65
  v_cvt_pk_bf16_f32 v93, v66, v67
  v_cvt_pk_bf16_f32 v94, v68, v69
  v_cvt_pk_bf16_f32 v95, v70, v71
  s_waitcnt lgkmcnt(5)
  v_mfma_f32_32x32x16_bf16 v[56:71], v[24:27], v[8:11], 0
  v_exp_f32 v72, v72
  v_exp_f32 v73, v73
  v_exp_f32 v74, v74
  v_exp_f32 v75, v75
  v_mfma_f32_32x32x16_bf16 v[96:111], v[52:55], v[92:95], v[96:111]
  v_exp_f32 v76, v76
  v_exp_f32 v77, v77
  v_exp_f32 v78, v78
  v_exp_f32 v79, v79
  s_waitcnt lgkmcnt(4)
  v_cvt_pk_bf16_f32 v88, v72, v73
  v_cvt_pk_bf16_f32 v89, v74, v75
  v_cvt_pk_bf16_f32 v90, v76, v77
  v_cvt_pk_bf16_f32 v91, v78, v79
  v_mfma_f32_32x32x16_bf16 v[56:71], v[32:35], v[12:15], v[56:71]
  v_exp_f32 v80, v80
  v_exp_f32 v81, v81
  v_exp_f32 v82, v82
  v_exp_f32 v83, v83
  v_mfma_f32_32x32x16_bf16 v[112:127], v[48:51], v[88:91], v[112:127]
  v_exp_f32 v84, v84
  v_exp_f32 v85, v85
  v_exp_f32 v86, v86
  v_exp_f32 v87, v87
  v_add_u32 v128, 4992, v128
  v_add_u32 v129, 4992, v129
  v_add_u32 v130, 4992, v130
  s_sub_u32 s40, s40, 1
  s_cmp_lg_u32 s40, 0
  v_cvt_pk_bf16_f32 v92, v80, v81
  v_cvt_pk_bf16_f32 v93, v82, v83
  v_cvt_pk_bf16_f32 v94, v84, v85
  v_cvt_pk_bf16_f32 v95, v86, v87
  s_cbranch_scc1 L_k3_ls
L_k3_done:
  s_waitcnt lgkmcnt(0)
  v_mfma_f32_32x32x16_bf16 v[112:127], v[52:55], v[92:95], v[112:127]
  s_cmp_eq_u32 s48, 0
  s_cbranch_scc1 L_k3_fin
  s_mov_b32 s48, 0
  s_nop 11
  v_mov_b32 v148, 0xff7fffff
  v_mov_b32 v149, 0xff7fffff
  v_mov_b32 v150, v7
  v_subrev_u32 v151, s7, v129
  v_subrev_u32 v151, 79872, v151
  s_mov_b32 s40, 0
L_k3_pre:
  ds_read_b128 v[24:27], v150
  ds_read_b64 v[32:33], v151
  v_add_u32 v150, 2496, v150
  v_add_u32 v151, 2496, v151
  s_waitcnt lgkmcnt(0)
  v_mfma_f32_32x32x16_bf16 v[56:71], v[24:27], v[8:11], 0
  v_mfma_f32_32x32x16_bf16 v[56:71], v[32:35], v[12:15], v[56:71]
  v_mfma_f32_32x32x16_bf16 v[72:87], v[24:27], v[16:19], 0
  v_mfma_f32_32x32x16_bf16 v[72:87], v[32:35], v[20:23], v[72:87]
  s_nop 12
  v_max3_f32 v148, v56, v57, v148
  v_max3_f32 v148, v58, v59, v148
  v_max3_f32 v148, v60, v61, v148
  v_max3_f32 v148, v62, v63, v148
  v_max3_f32 v148, v64, v65, v148
  v_max3_f32 v148, v66, v67, v148
  v_max3_f32 v148, v68, v69, v148
  v_max3_f32 v148, v70, v71, v148
  v_max3_f32 v149, v72, v73, v149
  v_max3_f32 v149, v74, v75, v149
  v_max3_f32 v149, v76, v77, v149
  v_max3_f32 v149, v78, v79, v149
  v_max3_f32 v149, v80, v81, v149
  v_max3_f32 v149, v82, v83, v149
  v_max3_f32 v149, v84, v85, v149
  v_max3_f32 v149, v86, v87, v149
  s_add_u32 s40, s40, 1
  s_cmp_lt_u32 s40, 64
  s_cbranch_scc1 L_k3_pre
  v_xor_b32 v154, 32, v1
  v_lshlrev_b32 v154, 2, v154
  v_cmp_eq_u32 vcc, 0, v4
  ds_bpermute_b32 v150, v154, v148
  ds_bpermute_b32 v151, v154, v149
  s_waitcnt lgkmcnt(0)
  v_max_f32 v148, v148, v150
  v_sub_f32 v148, 0, v148
  v_cvt_pk_bf16_f32 v152, v148, v148
  v_lshlrev_b32 v152, 16, v152
  v_sub_f32 v153, v148, v152
  v_cvt_pk_bf16_f32 v152, v152, v153
  v_cndmask_b32 v13, 0, v152, vcc
  v_max_f32 v149, v149, v151
  v_sub_f32 v149, 0, v149
  v_cvt_pk_bf16_f32 v152, v149, v149
  v_lshlrev_b32 v152, 16, v152
  v_sub_f32 v153, v149, v152
  v_cvt_pk_bf16_f32 v152, v152, v153
  v_cndmask_b32 v21, 0, v152, vcc
  v_mov_b32 v96, 0
  v_mov_b32 v97, 0
  v_mov_b32 v98, 0
  v_mov_b32 v99, 0
  v_mov_b32 v100, 0
  v_mov_b32 v101, 0
  v_mov_b32 v102, 0
  v_mov_b32 v103, 0
  v_mov_b32 v104, 0
  v_mov_b32 v105, 0
  v_mov_b32 v106, 0
  v_mov_b32 v107, 0
  v_mov_b32 v108, 0
  v_mov_b32 v109, 0
  v_mov_b32 v110, 0
  v_mov_b32 v111, 0
  v_mov_b32 v112, 0
  v_mov_b32 v113, 0
  v_mov_b32 v114, 0
  v_mov_b32 v115, 0
  v_mov_b32 v116, 0
  v_mov_b32 v117, 0
  v_mov_b32 v118, 0
  v_mov_b32 v119, 0
  v_mov_b32 v120, 0
  v_mov_b32 v121, 0
  v_mov_b32 v122, 0
  v_mov_b32 v123, 0
  v_mov_b32 v124, 0
  v_mov_b32 v125, 0
  v_mov_b32 v126, 0
  v_mov_b32 v127, 0
  v_mov_b32 v92, 0
  v_mov_b32 v52, 0
  v_mov_b32 v93, 0
  v_mov_b32 v53, 0
  v_mov_b32 v94, 0
  v_mov_b32 v54, 0
  v_mov_b32 v95, 0
  v_mov_b32 v55, 0
  v_subrev_u32 v128, 79872, v128
  v_subrev_u32 v129, 79872, v129
  v_subrev_u32 v130, 79872, v130
  ds_read_b128 v[24:27], v128 offset:0
  ds_read_b64 v[32:33], v129 offset:0
  s_mov_b64 exec, s[58:59]
  ds_read_b128 v[40:43], v130 offset:0
  ds_read_b128 v[44:47], v130 offset:608
  s_mov_b64 exec, -1
  ds_read_b128 v[28:31], v128 offset:2496
  ds_read_b64 v[36:37], v129 offset:2496
  s_waitcnt lgkmcnt(4)
  v_mfma_f32_32x32x16_bf16 v[56:71], v[24:27], v[8:11], 0
  v_mfma_f32_32x32x16_bf16 v[56:71], v[32:35], v[12:15], v[56:71]
  s_nop 9
  s_mov_b32 s43, 0
  s_mov_b32 s40, 16
  s_branch L_k3_plain
L_k3_fin:
  s_nop 11
  s_setprio 0
  s_barrier
  s_lshl_b32 s40, s3, 12
  v_add_u32 v148, s40, v7
  s_xor_b32 s40, s3, 4
  s_lshl_b32 s40, s40, 12
  v_add_u32 v149, s40, v7
  s_cmp_eq_u32 s5, 0
  s_cbranch_scc1 L_k3_h0
  v_swap_b32 v96, v112
  v_swap_b32 v97, v113
  v_swap_b32 v98, v114
  v_swap_b32 v99, v115
  v_swap_b32 v100, v116
  v_swap_b32 v101, v117
  v_swap_b32 v102, v118
  v_swap_b32 v103, v119
  v_swap_b32 v104, v120
  v_swap_b32 v105, v121
  v_swap_b32 v106, v122
  v_swap_b32 v107, v123
  s_mov_b32 s22, s6
L_k3_h0:
  ds_write_b128 v148, v[112:115] offset:0
  ds_write_b128 v148, v[116:119] offset:1024
  ds_write_b128 v148, v[120:123] offset:2048
  s_waitcnt lgkmcnt(0)
  s_barrier
  ds_read_b128 v[112:115], v149 offset:0
  ds_read_b128 v[116:119], v149 offset:1024
  ds_read_b128 v[120:123], v149 offset:2048
  s_add_u32 s12, s20, 3964928
  s_addc_u32 s13, s21, 0
  s_mov_b32 s14, 73728
  s_mov_b32 s15, 0x20000
  v_lshlrev_b32 v150, 2, v3
  v_mul_u32_u24 v5, 36, v3
  v_lshl_add_u32 v5, v4, 3, v5
  s_waitcnt lgkmcnt(0)
  v_add_f32 v96, v96, v112
  v_add_f32 v97, v97, v113
  v_add_f32 v98, v98, v114
  v_add_f32 v99, v99, v115
  v_add_f32 v100, v100, v116
  v_add_f32 v101, v101, v117
  v_add_f32 v102, v102, v118
  v_add_f32 v103, v103, v119
  v_add_f32 v104, v104, v120
  v_add_f32 v105, v105, v121
  v_add_f32 v106, v106, v122
  ds_bpermute_b32 v151, v150, v106
  s_waitcnt lgkmcnt(0)
  v_rcp_f32 v151, v151
  s_nop 0
  v_mul_f32 v96, v96, v151
  v_mul_f32 v97, v97, v151
  v_mul_f32 v98, v98, v151
  v_mul_f32 v99, v99, v151
  v_mul_f32 v100, v100, v151
  v_mul_f32 v101, v101, v151
  v_mul_f32 v102, v102, v151
  v_mul_f32 v103, v103, v151
  v_mul_f32 v104, v104, v151
  v_mul_f32 v105, v105, v151
  v_cvt_pk_bf16_f32 v88, v96, v97
  v_cvt_pk_bf16_f32 v89, v98, v99
  v_cvt_pk_bf16_f32 v90, v100, v101
  v_cvt_pk_bf16_f32 v91, v102, v103
  v_cvt_pk_bf16_f32 v92, v104, v105
  buffer_store_dwordx2 v[88:89], v5, s[36:39], s22 offen
  buffer_store_dwordx2 v[90:91], v5, s[36:39], s22 offen offset:16
  v_cmp_eq_u32 vcc, 0, v4
  s_and_saveexec_b64 s[42:43], vcc
  buffer_store_dword v92, v5, s[36:39], s22 offen offset:32
  s_mov_b64 exec, s[42:43]
  s_cmp_eq_u32 s50, 0
  s_cbranch_scc1 L_k3_end
  s_cmp_ge_u32 s3, 4
  s_cbranch_scc1 L_k3_end
  s_lshl_b32 s40, s51, 1
  s_mul_i32 s40, s40, 18432
  s_lshl_b32 s41, s77, 6
  s_add_u32 s40, s40, s41
  v_and_b32 v136, 15, v1
  v_lshrrev_b32 v137, 4, v1
  s_movk_i32 s41, 18432
  v_mul_lo_u32 v138, v136, s41
  v_lshl_add_u32 v138, v137, 4, v138
  v_cmp_gt_u32 vcc, 2, v136
  s_and_saveexec_b64 s[42:43], vcc
  buffer_store_dwordx4 v[140:143], v138, s[12:15], s40 offen
L_k3_end:
  s_endpgm
.globl wo_kernel
.p2align 8
.type wo_kernel,@function
wo_kernel:
  s_load_dwordx2 s[4:5], s[0:1], 0
  s_load_dwordx2 s[20:21], s[0:1], 104
  v_and_b32 v1, 63, v0
  v_lshrrev_b32 v2, 6, v0
  s_nop 0
  v_readfirstlane_b32 s3, v2
  s_cmp_ge_u32 s2, 256
  s_cbranch_scc1 L_k4_end
  s_movk_i32 s22, 911
  v_mul_lo_u32 v2, v0, s22
  v_lshrrev_b32 v2, 16, v2
  v_mul_u32_u24 v3, 72, v2
  v_sub_u32 v3, v0, v3
  s_and_b32 s22, s2, 7
  s_lshl_b32 s22, s22, 3
  s_lshr_b32 s23, s2, 3
  s_and_b32 s23, s23, 7
  s_add_u32 s22, s22, s23
  s_lshr_b32 s49, s2, 6
  s_mul_i32 s23, s49, 9
  s_add_u32 s23, s23, s3
  s_waitcnt lgkmcnt(0)
  s_mov_b32 s24, s4
  s_mov_b32 s25, s5
  s_mov_b32 s26, 2359296
  s_mov_b32 s27, 0x20000
  s_add_u32 s28, s20, 4038656
  s_addc_u32 s29, s21, 0
  s_mov_b32 s30, 2359296
  s_mov_b32 s31, 0x20000
  s_mov_b32 s32, s20
  s_mov_b32 s33, s21
  s_mov_b32 s34, 13824
  s_mov_b32 s35, 0x20000
  s_add_u32 s36, s20, 774144
  s_addc_u32 s37, s21, 0
  s_mov_b32 s38, 663552
  s_mov_b32 s39, 0x20000
  v_mul_u32_u24 v4, 1152, v2
  v_lshl_add_u32 v4, v3, 4, v4
  s_mul_i32 s40, s22, 36864
  s_mov_b32 s41, s40
  buffer_load_dwordx4 v[80:83], v4, s[28:31], s40 offen
  s_add_u32 s40, s40, 9216
  buffer_load_dwordx4 v[84:87], v4, s[28:31], s40 offen
  s_add_u32 s40, s40, 9216
  buffer_load_dwordx4 v[88:91], v4, s[28:31], s40 offen
  s_add_u32 s40, s40, 9216
  buffer_load_dwordx4 v[92:95], v4, s[28:31], s40 offen
  v_and_b32 v5, 15, v1
  v_lshrrev_b32 v6, 4, v1
  v_mul_u32_u24 v124, 1152, v5
  v_lshl_add_u32 v124, v6, 3, v124
  s_lshl_b32 s42, s23, 5
  s_add_u32 s41, s41, s42
  s_add_u32 s42, s41, 18432
  v_lshlrev_b32 v125, 4, v6
  s_lshl_b32 s43, s23, 6
  s_add_u32 s43, s43, 4608
  s_add_u32 s44, s43, 4608
  buffer_load_dwordx2 v[112:113], v124, s[24:27], s41 offen
  buffer_load_dwordx2 v[114:115], v124, s[24:27], s42 offen
  buffer_load_dwordx4 v[116:119], v125, s[32:35], s43 offen
  buffer_load_dwordx4 v[120:123], v125, s[32:35], s44 offen
  v_lshlrev_b32 v7, 4, v1
  s_mul_i32 s40, s23, 18432
  v_xor_b32 v5, v3, v2
  v_mul_u32_u24 v4, 1152, v2
  v_lshl_add_u32 v4, v5, 4, v4
  buffer_load_dwordx4 v[8:11], v7, s[36:39], s40 offen offset:0
  buffer_load_dwordx4 v[12:15], v7, s[36:39], s40 offen offset:1024
  buffer_load_dwordx4 v[16:19], v7, s[36:39], s40 offen offset:2048
  buffer_load_dwordx4 v[20:23], v7, s[36:39], s40 offen offset:3072
  s_add_u32 s40, s40, 4096
  buffer_load_dwordx4 v[24:27], v7, s[36:39], s40 offen offset:0
  buffer_load_dwordx4 v[28:31], v7, s[36:39], s40 offen offset:1024
  buffer_load_dwordx4 v[32:35], v7, s[36:39], s40 offen offset:2048
  buffer_load_dwordx4 v[36:39], v7, s[36:39], s40 offen offset:3072
  s_add_u32 s40, s40, 4096
  s_waitcnt vmcnt(15)
  ds_write_b128 v4, v[80:83] offset:0
  s_waitcnt vmcnt(14)
  ds_write_b128 v4, v[84:87] offset:9216
  s_waitcnt vmcnt(13)
  ds_write_b128 v4, v[88:91] offset:18432
  s_waitcnt vmcnt(12)
  ds_write_b128 v4, v[92:95] offset:27648
  s_waitcnt lgkmcnt(0)
  s_barrier
  buffer_load_dwordx4 v[40:43], v7, s[36:39], s40 offen offset:0
  buffer_load_dwordx4 v[44:47], v7, s[36:39], s40 offen offset:1024
  buffer_load_dwordx4 v[48:51], v7, s[36:39], s40 offen offset:2048
  buffer_load_dwordx4 v[52:55], v7, s[36:39], s40 offen offset:3072
  s_add_u32 s40, s40, 4096
  buffer_load_dwordx4 v[56:59], v7, s[36:39], s40 offen offset:0
  buffer_load_dwordx4 v[60:63], v7, s[36:39], s40 offen offset:1024
  buffer_load_dwordx4 v[64:67], v7, s[36:39], s40 offen offset:2048
  buffer_load_dwordx4 v[68:71], v7, s[36:39], s40 offen offset:3072
  s_add_u32 s40, s40, 4096
  buffer_load_dwordx4 v[72:75], v7, s[36:39], s40 offen offset:0
  buffer_load_dwordx4 v[76:79], v7, s[36:39], s40 offen offset:1024
  v_and_b32 v3, 15, v1
  v_lshrrev_b32 v4, 4, v1
  v_and_b32 v7, 7, v3
  v_xor_b32 v5, v4, v7
  v_xor_b32 v6, 4, v5
  v_mul_u32_u24 v7, 1152, v3
  v_lshl_add_u32 v5, v5, 4, v7
  v_lshl_add_u32 v6, v6, 4, v7
  ds_read_b128 v[80:83], v5 offset:0
  ds_read_b128 v[84:87], v5 offset:18432
  ds_read_b128 v[88:91], v6 offset:0
  ds_read_b128 v[92:95], v6 offset:18432
  ds_read_b128 v[96:99], v5 offset:128
  ds_read_b128 v[100:103], v5 offset:18560
  s_waitcnt lgkmcnt(5)
  s_waitcnt vmcnt(17)
  v_mfma_f32_16x16x32_bf16 v[104:107], v[8:11], v[80:83], 0
  ds_read_b128 v[80:83], v6 offset:128
  s_waitcnt lgkmcnt(5)
  v_mfma_f32_16x16x32_bf16 v[108:111], v[8:11], v[84:87], 0
  ds_read_b128 v[84:87], v6 offset:18560
  s_waitcnt lgkmcnt(5)
  s_waitcnt vmcnt(16)
  v_mfma_f32_16x16x32_bf16 v[104:107], v[12:15], v[88:91], v[104:107]
  ds_read_b128 v[88:91], v5 offset:256
  s_waitcnt lgkmcnt(5)
  v_mfma_f32_16x16x32_bf16 v[108:111], v[12:15], v[92:95], v[108:111]
  ds_read_b128 v[92:95], v5 offset:18688
  s_waitcnt lgkmcnt(5)
  s_waitcnt vmcnt(15)
  v_mfma_f32_16x16x32_bf16 v[104:107], v[16:19], v[96:99], v[104:107]
  ds_read_b128 v[96:99], v6 offset:256
  s_waitcnt lgkmcnt(5)
  v_mfma_f32_16x16x32_bf16 v[108:111], v[16:19], v[100:103], v[108:111]
  ds_read_b128 v[100:103], v6 offset:18688
  s_waitcnt lgkmcnt(5)
  s_waitcnt vmcnt(14)
  v_mfma_f32_16x16x32_bf16 v[104:107], v[20:23], v[80:83], v[104:107]
  ds_read_b128 v[80:83], v5 offset:384
  s_waitcnt lgkmcnt(5)
  v_mfma_f32_16x16x32_bf16 v[108:111], v[20:23], v[84:87], v[108:111]
  ds_read_b128 v[84:87], v5 offset:18816
  s_waitcnt lgkmcnt(5)
  s_waitcnt vmcnt(13)
  v_mfma_f32_16x16x32_bf16 v[104:107], v[24:27], v[88:91], v[104:107]
  ds_read_b128 v[88:91], v6 offset:384
  s_waitcnt lgkmcnt(5)
  v_mfma_f32_16x16x32_bf16 v[108:111], v[24:27], v[92:95], v[108:111]
  ds_read_b128 v[92:95], v6 offset:18816
  s_waitcnt lgkmcnt(5)
  s_waitcnt vmcnt(12)
  v_mfma_f32_16x16x32_bf16 v[104:107], v[28:31], v[96:99], v[104:107]
  ds_read_b128 v[96:99], v5 offset:512
  s_waitcnt lgkmcnt(5)
  v_mfma_f32_16x16x32_bf16 v[108:111], v[28:31], v[100:103], v[108:111]
  ds_read_b128 v[100:103], v5 offset:18944
  s_waitcnt lgkmcnt(5)
  s_waitcnt vmcnt(11)
  v_mfma_f32_16x16x32_bf16 v[104:107], v[32:35], v[80:83], v[104:107]
  ds_read_b128 v[80:83], v6 offset:512
  s_waitcnt lgkmcnt(5)
  v_mfma_f32_16x16x32_bf16 v[108:111], v[32:35], v[84:87], v[108:111]
  ds_read_b128 v[84:87], v6 offset:18944
  s_waitcnt lgkmcnt(5)
  s_waitcnt vmcnt(10)
  v_mfma_f32_16x16x32_bf16 v[104:107], v[36:39], v[88:91], v[104:107]
  ds_read_b128 v[88:91], v5 offset:640
  s_waitcnt lgkmcnt(5)
  v_mfma_f32_16x16x32_bf16 v[108:111], v[36:39], v[92:95], v[108:111]
  ds_read_b128 v[92:95], v5 offset:19072
  s_waitcnt lgkmcnt(5)
  s_waitcnt vmcnt(9)
  v_mfma_f32_16x16x32_bf16 v[104:107], v[40:43], v[96:99], v[104:107]
  ds_read_b128 v[96:99], v6 offset:640
  s_waitcnt lgkmcnt(5)
  v_mfma_f32_16x16x32_bf16 v[108:111], v[40:43], v[100:103], v[108:111]
  ds_read_b128 v[100:103], v6 offset:19072
  s_waitcnt lgkmcnt(5)
  s_waitcnt vmcnt(8)
  v_mfma_f32_16x16x32_bf16 v[104:107], v[44:47], v[80:83], v[104:107]
  ds_read_b128 v[80:83], v5 offset:768
  s_waitcnt lgkmcnt(5)
  v_mfma_f32_16x16x32_bf16 v[108:111], v[44:47], v[84:87], v[108:111]
  ds_read_b128 v[84:87], v5 offset:19200
  s_waitcnt lgkmcnt(5)
  s_waitcnt vmcnt(7)
  v_mfma_f32_16x16x32_bf16 v[104:107], v[48:51], v[88:91], v[104:107]
  ds_read_b128 v[88:91], v6 offset:768
  s_waitcnt lgkmcnt(5)
  v_mfma_f32_16x16x32_bf16 v[108:111], v[48:51], v[92:95], v[108:111]
  ds_read_b128 v[92:95], v6 offset:19200
  s_waitcnt lgkmcnt(5)
  s_waitcnt vmcnt(6)
  v_mfma_f32_16x16x32_bf16 v[104:107], v[52:55], v[96:99], v[104:107]
  ds_read_b128 v[96:99], v5 offset:896
  s_waitcnt lgkmcnt(5)
  v_mfma_f32_16x16x32_bf16 v[108:111], v[52:55], v[100:103], v[108:111]
  ds_read_b128 v[100:103], v5 offset:19328
  s_waitcnt lgkmcnt(5)
  s_waitcnt vmcnt(5)
  v_mfma_f32_16x16x32_bf16 v[104:107], v[56:59], v[80:83], v[104:107]
  ds_read_b128 v[80:83], v6 offset:896
  s_waitcnt lgkmcnt(5)
  v_mfma_f32_16x16x32_bf16 v[108:111], v[56:59], v[84:87], v[108:111]
  ds_read_b128 v[84:87], v6 offset:19328
  s_waitcnt lgkmcnt(5)
  s_waitcnt vmcnt(4)
  v_mfma_f32_16x16x32_bf16 v[104:107], v[60:63], v[88:91], v[104:107]
  ds_read_b128 v[88:91], v5 offset:1024
  s_waitcnt lgkmcnt(5)
  v_mfma_f32_16x16x32_bf16 v[108:111], v[60:63], v[92:95], v[108:111]
  ds_read_b128 v[92:95], v5 offset:19456
  s_waitcnt lgkmcnt(5)
  s_waitcnt vmcnt(3)
  v_mfma_f32_16x16x32_bf16 v[104:107], v[64:67], v[96:99], v[104:107]
  ds_read_b128 v[96:99], v6 offset:1024
  s_waitcnt lgkmcnt(5)
  v_mfma_f32_16x16x32_bf16 v[108:111], v[64:67], v[100:103], v[108:111]
  ds_read_b128 v[100:103], v6 offset:19456
  s_waitcnt lgkmcnt(5)
  s_waitcnt vmcnt(2)
  v_mfma_f32_16x16x32_bf16 v[104:107], v[68:71], v[80:83], v[104:107]
  s_waitcnt lgkmcnt(4)
  v_mfma_f32_16x16x32_bf16 v[108:111], v[68:71], v[84:87], v[108:111]
  s_waitcnt lgkmcnt(3)
  s_waitcnt vmcnt(1)
  v_mfma_f32_16x16x32_bf16 v[104:107], v[72:75], v[88:91], v[104:107]
  s_waitcnt lgkmcnt(2)
  v_mfma_f32_16x16x32_bf16 v[108:111], v[72:75], v[92:95], v[108:111]
  s_waitcnt lgkmcnt(1)
  s_waitcnt vmcnt(0)
  v_mfma_f32_16x16x32_bf16 v[104:107], v[76:79], v[96:99], v[104:107]
  s_waitcnt lgkmcnt(0)
  v_mfma_f32_16x16x32_bf16 v[108:111], v[76:79], v[100:103], v[108:111]
  s_nop 7
  s_add_u32 s24, s20, 6397952
  s_addc_u32 s25, s21, 0
  s_mov_b32 s26, 2359296
  s_mov_b32 s27, 0x20000
  s_add_u32 s28, s20, 8757248
  s_addc_u32 s29, s21, 0
  s_mov_b32 s30, 2359296
  s_mov_b32 s31, 0x20000
  s_add_u32 s32, s20, 11116544
  s_addc_u32 s33, s21, 0
  s_mov_b32 s34, 65536
  s_mov_b32 s35, 0x20000
  s_and_b32 s45, s23, 1
  s_lshl_b32 s45, s45, 1
  v_lshrrev_b32 v125, 1, v4
  v_add_u32 v125, s45, v125
  v_lshrrev_b32 v126, 2, v3
  v_sub_u32 v126, 4, v126
  v_xor_b32 v125, v125, v126
  v_and_b32 v125, 3, v125
  v_lshlrev_b32 v125, 4, v125
  v_lshl_add_u32 v125, v3, 6, v125
  v_and_b32 v126, 1, v4
  v_lshl_add_u32 v125, v126, 3, v125
  s_lshr_b32 s45, s22, 3
  s_lshr_b32 s46, s23, 1
  s_lshl_b32 s46, s46, 3
  s_add_u32 s45, s45, s46
  s_lshl_b32 s45, s45, 14
  s_and_b32 s46, s22, 7
  s_lshl_b32 s46, s46, 11
  s_add_u32 s45, s45, s46
  v_lshlrev_b32 v80, 16, v112
  v_and_b32 v81, 0xffff0000, v112
  v_lshlrev_b32 v82, 16, v113
  v_and_b32 v83, 0xffff0000, v113
  v_fmac_f32 v80, v116, v104
  v_fmac_f32 v81, v117, v105
  v_fmac_f32 v82, v118, v106
  v_fmac_f32 v83, v119, v107
  v_cvt_pk_bf16_f32 v84, v80, v81
  v_cvt_pk_bf16_f32 v85, v82, v83
  v_lshlrev_b32 v80, 16, v84
  v_and_b32 v81, 0xffff0000, v84
  v_lshlrev_b32 v82, 16, v85
  v_and_b32 v83, 0xffff0000, v85
  v_add_f32 v88, v80, v81
  v_add_f32 v89, v82, v83
  v_add_f32 v88, v88, v89
  v_mul_f32 v89, v80, v80
  v_fmac_f32 v89, v81, v81
  v_fmac_f32 v89, v82, v82
  v_fmac_f32 v89, v83, v83
  v_mul_f32 v80, v80, v120
  v_mul_f32 v81, v81, v121
  v_mul_f32 v82, v82, v122
  v_mul_f32 v83, v83, v123
  v_cvt_pk_bf16_f32 v86, v80, v81
  v_cvt_pk_bf16_f32 v87, v82, v83
  buffer_store_dwordx2 v[84:85], v124, s[24:27], s41 offen
  buffer_store_dwordx2 v[86:87], v125, s[28:31], s45 offen offset:0
  v_lshlrev_b32 v80, 16, v114
  v_and_b32 v81, 0xffff0000, v114
  v_lshlrev_b32 v82, 16, v115
  v_and_b32 v83, 0xffff0000, v115
  v_fmac_f32 v80, v116, v108
  v_fmac_f32 v81, v117, v109
  v_fmac_f32 v82, v118, v110
  v_fmac_f32 v83, v119, v111
  v_cvt_pk_bf16_f32 v92, v80, v81
  v_cvt_pk_bf16_f32 v93, v82, v83
  v_lshlrev_b32 v80, 16, v92
  v_and_b32 v81, 0xffff0000, v92
  v_lshlrev_b32 v82, 16, v93
  v_and_b32 v83, 0xffff0000, v93
  v_add_f32 v96, v80, v81
  v_add_f32 v97, v82, v83
  v_add_f32 v96, v96, v97
  v_mul_f32 v97, v80, v80
  v_fmac_f32 v97, v81, v81
  v_fmac_f32 v97, v82, v82
  v_fmac_f32 v97, v83, v83
  v_mul_f32 v80, v80, v120
  v_mul_f32 v81, v81, v121
  v_mul_f32 v82, v82, v122
  v_mul_f32 v83, v83, v123
  v_cvt_pk_bf16_f32 v94, v80, v81
  v_cvt_pk_bf16_f32 v95, v82, v83
  buffer_store_dwordx2 v[92:93], v124, s[24:27], s42 offen
  buffer_store_dwordx2 v[94:95], v125, s[28:31], s45 offen offset:1024
  s_lshl_b32 s40, s3, 2
  v_add_u32 v7, s40, v4
  v_lshlrev_b32 v7, 8, v7
  v_lshl_add_u32 v7, v3, 3, v7
  ds_write_b64 v7, v[88:89] offset:36864
  ds_write_b64 v7, v[96:97] offset:36992
  s_waitcnt lgkmcnt(0)
  s_barrier
  s_cmp_lg_u32 s3, 0
  s_cbranch_scc1 L_k4_end
  v_lshlrev_b32 v7, 2, v1
  ds_read_b32 v8, v7 offset:36864
  ds_read_b32 v9, v7 offset:37120
  ds_read_b32 v10, v7 offset:37376
  ds_read_b32 v11, v7 offset:37632
  ds_read_b32 v12, v7 offset:37888
  ds_read_b32 v13, v7 offset:38144
  ds_read_b32 v14, v7 offset:38400
  ds_read_b32 v15, v7 offset:38656
  ds_read_b32 v16, v7 offset:38912
  ds_read_b32 v17, v7 offset:39168
  ds_read_b32 v18, v7 offset:39424
  ds_read_b32 v19, v7 offset:39680
  s_waitcnt lgkmcnt(0)
  ds_read_b32 v20, v7 offset:39936
  ds_read_b32 v21, v7 offset:40192
  ds_read_b32 v22, v7 offset:40448
  ds_read_b32 v23, v7 offset:40704
  ds_read_b32 v24, v7 offset:40960
  ds_read_b32 v25, v7 offset:41216
  ds_read_b32 v26, v7 offset:41472
  ds_read_b32 v27, v7 offset:41728
  ds_read_b32 v28, v7 offset:41984
  ds_read_b32 v29, v7 offset:42240
  ds_read_b32 v30, v7 offset:42496
  ds_read_b32 v31, v7 offset:42752
  s_waitcnt lgkmcnt(0)
  ds_read_b32 v32, v7 offset:43008
  ds_read_b32 v33, v7 offset:43264
  ds_read_b32 v34, v7 offset:43520
  ds_read_b32 v35, v7 offset:43776
  ds_read_b32 v36, v7 offset:44032
  ds_read_b32 v37, v7 offset:44288
  ds_read_b32 v38, v7 offset:44544
  ds_read_b32 v39, v7 offset:44800
  ds_read_b32 v40, v7 offset:45056
  ds_read_b32 v41, v7 offset:45312
  ds_read_b32 v42, v7 offset:45568
  ds_read_b32 v43, v7 offset:45824
  s_waitcnt lgkmcnt(0)
  v_add_f32 v8, v8, v12
  v_add_f32 v8, v8, v16
  v_add_f32 v8, v8, v20
  v_add_f32 v8, v8, v24
  v_add_f32 v8, v8, v28
  v_add_f32 v8, v8, v32
  v_add_f32 v8, v8, v36
  v_add_f32 v8, v8, v40
  v_add_f32 v9, v9, v13
  v_add_f32 v9, v9, v17
  v_add_f32 v9, v9, v21
  v_add_f32 v9, v9, v25
  v_add_f32 v9, v9, v29
  v_add_f32 v9, v9, v33
  v_add_f32 v9, v9, v37
  v_add_f32 v9, v9, v41
  v_add_f32 v10, v10, v14
  v_add_f32 v10, v10, v18
  v_add_f32 v10, v10, v22
  v_add_f32 v10, v10, v26
  v_add_f32 v10, v10, v30
  v_add_f32 v10, v10, v34
  v_add_f32 v10, v10, v38
  v_add_f32 v10, v10, v42
  v_add_f32 v11, v11, v15
  v_add_f32 v11, v11, v19
  v_add_f32 v11, v11, v23
  v_add_f32 v11, v11, v27
  v_add_f32 v11, v11, v31
  v_add_f32 v11, v11, v35
  v_add_f32 v11, v11, v39
  v_add_f32 v11, v11, v43
  v_add_f32 v8, v8, v9
  v_add_f32 v10, v10, v11
  v_add_f32 v8, v8, v10
  v_lshrrev_b32 v5, 1, v1
  v_and_b32 v6, 1, v1
  v_lshlrev_b32 v5, 5, v5
  v_lshl_add_u32 v5, v6, 2, v5
  s_lshl_b32 s40, s22, 10
  s_lshl_b32 s41, s49, 3
  s_add_u32 s40, s40, s41
  buffer_store_dword v8, v5, s[32:35], s40 offen
L_k4_end:
  s_endpgm
.globl ffn1_kernel
.p2align 8
.type ffn1_kernel,@function
ffn1_kernel:
  s_load_dwordx4 s[8:11], s[0:1], 48
  s_load_dwordx2 s[20:21], s[0:1], 104
  v_and_b32 v1, 63, v0
  v_lshrrev_b32 v2, 6, v0
  v_lshlrev_b32 v7, 4, v1
  v_readfirstlane_b32 s3, v2
  s_cmp_ge_u32 s2, 256
  s_cbranch_scc1 L_k5_end
  s_and_b32 s22, s2, 7
  s_lshl_b32 s22, s22, 2
  s_lshr_b32 s23, s2, 3
  s_and_b32 s24, s23, 3
  s_add_u32 s22, s22, s24
  s_lshr_b32 s23, s23, 2
  s_and_b32 s24, s3, 3
  s_lshr_b32 s25, s3, 2
  s_lshl_b32 s26, s23, 8
  s_mul_i32 s27, s22, 144
  v_and_b32 v160, 15, v1
  v_lshrrev_b32 v161, 4, v1
  s_waitcnt lgkmcnt(0)
  s_cmp_ge_u32 s3, 3
  s_cbranch_scc1 L_k5_noaux
  s_mov_b32 s28, 11116544
  s_mov_b32 s30, 65536
  s_cmp_eq_u32 s3, 2
  s_cselect_b32 s28, 3964928, s28
  s_cselect_b32 s30, 73728, s30
  s_add_u32 s28, s20, s28
  s_addc_u32 s29, s21, 0
  s_mov_b32 s31, 0x20000
  s_lshl_b32 s40, s26, 5
  s_lshl_b32 s41, s3, 12
  s_add_u32 s40, s40, s41
  s_lshl_b32 s42, s27, 2
  s_movk_i32 s43, 1024
  s_cmp_eq_u32 s3, 2
  s_cselect_b32 s40, s42, s40
  s_cselect_b32 s43, 18432, s43
  s_add_u32 s41, s41, 147456
  s_add_u32 m0, s41, 0
  s_nop 0
  buffer_load_dwordx4 v7, s[28:31], s40 offen lds
  s_add_u32 s40, s40, s43
  s_add_u32 m0, s41, 1024
  s_nop 0
  buffer_load_dwordx4 v7, s[28:31], s40 offen lds
  s_add_u32 s40, s40, s43
  s_add_u32 m0, s41, 2048
  s_nop 0
  buffer_load_dwordx4 v7, s[28:31], s40 offen lds
  s_add_u32 s40, s40, s43
  s_add_u32 m0, s41, 3072
  s_nop 0
  buffer_load_dwordx4 v7, s[28:31], s40 offen lds
  s_add_u32 s40, s40, s43
L_k5_noaux:
  s_mul_i32 s66, s3, 3
  s_add_u32 s66, s66, 0
  s_lshl_b32 s62, s66, 10
  s_mov_b32 s47, 0x20000
  s_cmp_ge_u32 s66, 16
  s_cbranch_scc1 L_ffn1_kernel_dmaw_1
  s_add_u32 s44, s20, 8757248
  s_addc_u32 s45, s21, 0
  s_mov_b32 s46, 2359296
  s_lshl_b32 s56, s23, 14
  s_add_u32 s56, s56, s62
  s_mov_b32 s59, 131072
  v_lshlrev_b32 v166, 4, v1
  s_branch L_ffn1_kernel_dmad_2
L_ffn1_kernel_dmaw_1:
  s_cmp_ge_u32 s66, 26
  s_cselect_b32 s44, s10, s8
  s_cselect_b32 s45, s11, s9
  s_cselect_b32 s67, 26, 16
  s_mov_b32 s46, 5308416
  s_lshl_b32 s56, s27, 1
  s_mov_b32 s59, 294912
  s_sub_u32 s67, s66, s67
  s_lshl_b32 s67, s67, 6
  v_add_u32 v164, s67, v1
  v_mul_u32_u24 v165, 863, v164
  v_lshrrev_b32 v165, 17, v165
  v_mul_u32_u24 v167, 152, v165
  v_sub_u32 v164, v164, v167
  v_min_u32 v164, 143, v164
  v_min_u32 v165, 3, v165
  v_mul_u32_u24 v167, 3641, v164
  v_lshrrev_b32 v167, 16, v167
  v_lshl_add_u32 v165, v165, 3, v167
  v_mul_u32_u24 v167, 18, v167
  v_sub_u32 v164, v164, v167
  v_mul_u32_u24 v165, 9216, v165
  v_lshl_add_u32 v166, v164, 4, v165
L_ffn1_kernel_dmad_2:
  s_mul_i32 s66, s3, 3
  s_add_u32 s66, s66, 1
  s_lshl_b32 s63, s66, 10
  s_mov_b32 s51, 0x20000
  s_cmp_ge_u32 s66, 16
  s_cbranch_scc1 L_ffn1_kernel_dmaw_3
  s_add_u32 s48, s20, 8757248
  s_addc_u32 s49, s21, 0
  s_mov_b32 s50, 2359296
  s_lshl_b32 s57, s23, 14
  s_add_u32 s57, s57, s63
  s_mov_b32 s60, 131072
  v_lshlrev_b32 v159, 4, v1
  s_branch L_ffn1_kernel_dmad_4
L_ffn1_kernel_dmaw_3:
  s_cmp_ge_u32 s66, 26
  s_cselect_b32 s48, s10, s8
  s_cselect_b32 s49, s11, s9
  s_cselect_b32 s67, 26, 16
  s_mov_b32 s50, 5308416
  s_lshl_b32 s57, s27, 1
  s_mov_b32 s60, 294912
  s_sub_u32 s67, s66, s67
  s_lshl_b32 s67, s67, 6
  v_add_u32 v164, s67, v1
  v_mul_u32_u24 v165, 863, v164
  v_lshrrev_b32 v165, 17, v165
  v_mul_u32_u24 v167, 152, v165
  v_sub_u32 v164, v164, v167
  v_min_u32 v164, 143, v164
  v_min_u32 v165, 3, v165
  v_mul_u32_u24 v167, 3641, v164
  v_lshrrev_b32 v167, 16, v167
  v_lshl_add_u32 v165, v165, 3, v167
  v_mul_u32_u24 v167, 18, v167
  v_sub_u32 v164, v164, v167
  v_mul_u32_u24 v165, 9216, v165
  v_lshl_add_u32 v159, v164, 4, v165
L_ffn1_kernel_dmad_4:
  s_mul_i32 s66, s3, 3
  s_add_u32 s66, s66, 2
  s_lshl_b32 s64, s66, 10
  s_mov_b32 s55, 0x20000
  s_cmp_ge_u32 s66, 16
  s_cbranch_scc1 L_ffn1_kernel_dmaw_5
  s_add_u32 s52, s20, 8757248
  s_addc_u32 s53, s21, 0
  s_mov_b32 s54, 2359296
  s_lshl_b32 s58, s23, 14
  s_add_u32 s58, s58, s64
  s_mov_b32 s61, 131072
  v_lshlrev_b32 v2, 4, v1
  s_branch L_ffn1_kernel_dmad_6
L_ffn1_kernel_dmaw_5:
  s_cmp_ge_u32 s66, 26
  s_cselect_b32 s52, s10, s8
  s_cselect_b32 s53, s11, s9
  s_cselect_b32 s67, 26, 16
  s_mov_b32 s54, 5308416
  s_lshl_b32 s58, s27, 1
  s_mov_b32 s61, 294912
  s_sub_u32 s67, s66, s67
  s_lshl_b32 s67, s67, 6
  v_add_u32 v164, s67, v1
  v_mul_u32_u24 v165, 863, v164
  v_lshrrev_b32 v165, 17, v165
  v_mul_u32_u24 v167, 152, v165
  v_sub_u32 v164, v164, v167
  v_min_u32 v164, 143, v164
  v_min_u32 v165, 3, v165
  v_mul_u32_u24 v167, 3641, v164
  v_lshrrev_b32 v167, 16, v167
  v_lshl_add_u32 v165, v165, 3, v167
  v_mul_u32_u24 v167, 18, v167
  v_sub_u32 v164, v164, v167
  v_mul_u32_u24 v165, 9216, v165
  v_lshl_add_u32 v2, v164, 4, v165
L_ffn1_kernel_dmad_6:
  v_bfe_u32 v158, v1, 2, 2
  v_and_b32 v157, 3, v1
  v_mov_b32 v0, v166
  v_mov_b32 v1, v159
  s_mov_b32 s68, 0
  s_add_u32 m0, s62, s68
  s_nop 0
  buffer_load_dwordx4 v0, s[44:47], s56 offen lds
  s_add_u32 s56, s56, s59
  s_add_u32 m0, s63, s68
  s_nop 0
  buffer_load_dwordx4 v1, s[48:51], s57 offen lds
  s_add_u32 s57, s57, s60
  s_add_u32 m0, s64, s68
  s_nop 0
  buffer_load_dwordx4 v2, s[52:55], s58 offen lds
  s_add_u32 s58, s58, s61
  s_add_u32 s68, s68, 36864
  s_cmp_eq_u32 s68, 147456
  s_cselect_b32 s68, 0, s68
  s_add_u32 m0, s62, s68
  s_nop 0
  buffer_load_dwordx4 v0, s[44:47], s56 offen lds
  s_add_u32 s56, s56, s59
  s_add_u32 m0, s63, s68
  s_nop 0
  buffer_load_dwordx4 v1, s[48:51], s57 offen lds
  s_add_u32 s57, s57, s60
  s_add_u32 m0, s64, s68
  s_nop 0
  buffer_load_dwordx4 v2, s[52:55], s58 offen lds
  s_add_u32 s58, s58, s61
  s_add_u32 s68, s68, 36864
  s_cmp_eq_u32 s68, 147456
  s_cselect_b32 s68, 0, s68
  v_lshrrev_b32 v164, 2, v160
  v_sub_u32 v164, 4, v164
  v_xor_b32 v164, v164, v161
  v_and_b32 v164, 3, v164
  s_lshl_b32 s66, s24, 12
  v_lshlrev_b32 v3, 6, v160
  v_lshl_add_u32 v3, v164, 4, v3
  v_add_u32 v3, s66, v3
  v_add_u32 v4, 73728, v3
  v_lshl_add_u32 v164, v161, 3, v158
  v_mul_u32_u24 v164, 288, v164
  v_lshl_add_u32 v164, v161, 7, v164
  v_lshl_add_u32 v164, v157, 3, v164
  s_mul_i32 s66, s25, 96
  v_add_u32 v5, s66, v164
  v_add_u32 v6, 73728, v5
  s_lshl_b32 s66, s24, 11
  s_add_u32 s66, s66, 147456
  v_lshlrev_b32 v162, 5, v160
  v_add_u32 v162, s66, v162
  s_mul_i32 s66, s25, 192
  s_add_u32 s66, s66, 155648
  v_lshlrev_b32 v163, 4, v161
  v_add_u32 v163, s66, v163
  s_waitcnt vmcnt(6)
  s_barrier
  ds_read_b128 v[40:43], v162 offset:0
  ds_read_b128 v[44:47], v162 offset:16
  ds_read_b128 v[48:51], v162 offset:512
  ds_read_b128 v[52:55], v162 offset:528
  ds_read_b128 v[56:59], v162 offset:1024
  ds_read_b128 v[60:63], v162 offset:1040
  ds_read_b128 v[64:67], v162 offset:1536
  ds_read_b128 v[68:71], v162 offset:1552
  s_waitcnt lgkmcnt(0)
  ds_read_b128 v[76:79], v163 offset:0
  ds_read_b128 v[108:111], v163 offset:64
  ds_read_b128 v[140:143], v163 offset:128
  ds_read_b128 v[72:75], v163 offset:1024
  ds_read_b128 v[104:107], v163 offset:1088
  ds_read_b128 v[136:139], v163 offset:1152
  ds_read_b128 v[92:95], v163 offset:2048
  ds_read_b128 v[124:127], v163 offset:2112
  ds_read_b128 v[156:159], v163 offset:2176
  ds_read_b128 v[88:91], v163 offset:3072
  ds_read_b128 v[120:123], v163 offset:3136
  ds_read_b128 v[152:155], v163 offset:3200
  v_add_f32 v40, v40, v42
  v_add_f32 v48, v48, v50
  v_add_f32 v56, v56, v58
  v_add_f32 v64, v64, v66
  v_add_f32 v44, v44, v46
  v_add_f32 v52, v52, v54
  v_add_f32 v60, v60, v62
  v_add_f32 v68, v68, v70
  v_add_f32 v41, v41, v43
  v_add_f32 v49, v49, v51
  v_add_f32 v57, v57, v59
  v_add_f32 v65, v65, v67
  v_add_f32 v45, v45, v47
  v_add_f32 v53, v53, v55
  v_add_f32 v61, v61, v63
  v_add_f32 v69, v69, v71
  v_add_f32 v40, v40, v44
  v_add_f32 v48, v48, v52
  v_add_f32 v56, v56, v60
  v_add_f32 v64, v64, v68
  v_add_f32 v41, v41, v45
  v_add_f32 v49, v49, v53
  v_add_f32 v57, v57, v61
  v_add_f32 v65, v65, v69
  v_mul_f32 v40, 0xbae38e39, v40
  v_mul_f32 v48, 0xbae38e39, v48
  v_mul_f32 v56, 0xbae38e39, v56
  v_mul_f32 v64, 0xbae38e39, v64
  v_mul_f32 v41, 0x3ae38e39, v41
  v_mul_f32 v49, 0x3ae38e39, v49
  v_mul_f32 v57, 0x3ae38e39, v57
  v_mul_f32 v65, 0x3ae38e39, v65
  v_fma_f32 v41, -v40, v40, v41
  v_fma_f32 v49, -v48, v48, v49
  v_fma_f32 v57, -v56, v56, v57
  v_fma_f32 v65, -v64, v64, v65
  v_max_f32 v41, 0, v41
  v_max_f32 v49, 0, v49
  v_max_f32 v57, 0, v57
  v_max_f32 v65, 0, v65
  v_cvt_pk_bf16_f32 v42, v40, v40
  v_cvt_pk_bf16_f32 v50, v48, v48
  v_cvt_pk_bf16_f32 v58, v56, v56
  v_cvt_pk_bf16_f32 v66, v64, v64
  v_cvt_pk_bf16_f32 v41, v41, v41
  v_cvt_pk_bf16_f32 v49, v49, v49
  v_cvt_pk_bf16_f32 v57, v57, v57
  v_cvt_pk_bf16_f32 v65, v65, v65
  v_lshlrev_b32 v160, 16, v42
  v_lshlrev_b32 v161, 16, v50
  v_lshlrev_b32 v162, 16, v58
  v_lshlrev_b32 v163, 16, v66
  v_lshlrev_b32 v41, 16, v41
  v_lshlrev_b32 v49, 16, v49
  v_lshlrev_b32 v57, 16, v57
  v_lshlrev_b32 v65, 16, v65
  v_add_f32 v41, 0x3727c5ac, v41
  v_add_f32 v49, 0x3727c5ac, v49
  v_add_f32 v57, 0x3727c5ac, v57
  v_add_f32 v65, 0x3727c5ac, v65
  v_cvt_pk_bf16_f32 v41, v41, v41
  v_cvt_pk_bf16_f32 v49, v49, v49
  v_cvt_pk_bf16_f32 v57, v57, v57
  v_cvt_pk_bf16_f32 v65, v65, v65
  v_lshlrev_b32 v41, 16, v41
  v_lshlrev_b32 v49, 16, v49
  v_lshlrev_b32 v57, 16, v57
  v_lshlrev_b32 v65, 16, v65
  v_sqrt_f32 v41, v41
  v_sqrt_f32 v49, v49
  v_sqrt_f32 v57, v57
  v_sqrt_f32 v65, v65
  v_cvt_pk_bf16_f32 v41, v41, v41
  v_cvt_pk_bf16_f32 v49, v49, v49
  v_cvt_pk_bf16_f32 v57, v57, v57
  v_cvt_pk_bf16_f32 v65, v65, v65
  v_lshlrev_b32 v164, 16, v41
  v_lshlrev_b32 v165, 16, v49
  v_lshlrev_b32 v166, 16, v57
  v_lshlrev_b32 v167, 16, v65
  v_rcp_f32 v43, v164
  v_rcp_f32 v51, v165
  v_rcp_f32 v59, v166
  v_rcp_f32 v67, v167
  v_mul_f32 v8, 0xbfb8aa3b, v43
  v_mul_f32 v9, 0xbfb8aa3b, v51
  v_mul_f32 v10, 0xbfb8aa3b, v59
  v_mul_f32 v11, 0xbfb8aa3b, v67
  v_mul_f32 v12, v43, v43
  v_mul_f32 v13, v51, v51
  v_mul_f32 v14, v59, v59
  v_mul_f32 v15, v67, v67
  v_mov_b32 v64, v160
  v_mov_b32 v68, v164
  v_mov_b32 v65, v161
  v_mov_b32 v69, v165
  v_mov_b32 v66, v162
  v_mov_b32 v70, v166
  v_mov_b32 v67, v163
  v_mov_b32 v71, v167
  s_waitcnt vmcnt(3) lgkmcnt(0)
  s_barrier
  ds_read_b128 v[40:43], v3 offset:0
  ds_read_b128 v[44:47], v3 offset:1024
  ds_read_b128 v[48:51], v3 offset:2048
  ds_read_b128 v[52:55], v3 offset:3072
  ds_read_b64_tr_b16 v[16:17], v5 offset:16384
  ds_read_b64_tr_b16 v[18:19], v5 offset:17536
  ds_read_b64_tr_b16 v[20:21], v5 offset:26624
  ds_read_b64_tr_b16 v[22:23], v5 offset:27776
  ds_read_b64_tr_b16 v[24:25], v5 offset:16416
  ds_read_b64_tr_b16 v[26:27], v5 offset:17568
  ds_read_b64_tr_b16 v[28:29], v5 offset:26656
  ds_read_b64_tr_b16 v[30:31], v5 offset:27808
  ds_read_b64_tr_b16 v[32:33], v5 offset:16448
  ds_read_b64_tr_b16 v[34:35], v5 offset:17600
  ds_read_b64_tr_b16 v[36:37], v5 offset:26688
  ds_read_b64_tr_b16 v[38:39], v5 offset:27840
  v_mul_f32 v84, v72, v71
  v_mul_f32 v85, v73, v71
  v_mul_f32 v86, v74, v71
  v_mul_f32 v87, v75, v71
  v_fmac_f32 v84, v67, v76
  v_fmac_f32 v85, v67, v77
  v_fmac_f32 v86, v67, v78
  v_fmac_f32 v87, v67, v79
  v_mul_f32 v80, v72, v70
  v_mul_f32 v81, v73, v70
  v_mul_f32 v82, v74, v70
  v_mul_f32 v83, v75, v70
  v_fmac_f32 v80, v66, v76
  v_fmac_f32 v81, v66, v77
  v_fmac_f32 v82, v66, v78
  v_fmac_f32 v83, v66, v79
  v_mul_f32 v56, v72, v69
  v_mul_f32 v57, v73, v69
  v_mul_f32 v58, v74, v69
  v_mul_f32 v59, v75, v69
  v_mul_f32 v72, v72, v68
  v_mul_f32 v73, v73, v68
  v_mul_f32 v74, v74, v68
  v_mul_f32 v75, v75, v68
  v_fmac_f32 v72, v64, v76
  v_fmac_f32 v73, v64, v77
  v_fmac_f32 v74, v64, v78
  v_fmac_f32 v75, v64, v79
  v_fma_f32 v76, v65, v76, v56
  v_fma_f32 v77, v65, v77, v57
  v_fma_f32 v78, v65, v78, v58
  v_fma_f32 v79, v65, v79, v59
  s_nop 1
  s_waitcnt lgkmcnt(10)
  v_mfma_f32_16x16x32_bf16 v[84:87], v[16:19], v[52:55], v[84:87]
  v_mul_f32 v100, v88, v71
  v_mul_f32 v101, v89, v71
  v_mul_f32 v102, v90, v71
  v_mul_f32 v103, v91, v71
  v_fmac_f32 v100, v67, v92
  v_fmac_f32 v101, v67, v93
  v_fmac_f32 v102, v67, v94
  v_fmac_f32 v103, v67, v95
  v_mfma_f32_16x16x32_bf16 v[80:83], v[16:19], v[48:51], v[80:83]
  v_mul_f32 v96, v88, v70
  v_mul_f32 v97, v89, v70
  v_mul_f32 v98, v90, v70
  v_mul_f32 v99, v91, v70
  v_fmac_f32 v96, v66, v92
  v_fmac_f32 v97, v66, v93
  v_fmac_f32 v98, v66, v94
  v_fmac_f32 v99, v66, v95
  v_mfma_f32_16x16x32_bf16 v[76:79], v[16:19], v[44:47], v[76:79]
  v_mul_f32 v56, v88, v69
  v_mul_f32 v57, v89, v69
  v_mul_f32 v58, v90, v69
  v_mul_f32 v59, v91, v69
  v_mul_f32 v88, v88, v68
  v_mul_f32 v89, v89, v68
  v_mul_f32 v90, v90, v68
  v_mul_f32 v91, v91, v68
  v_mfma_f32_16x16x32_bf16 v[72:75], v[16:19], v[40:43], v[72:75]
  v_fmac_f32 v88, v64, v92
  v_fmac_f32 v89, v64, v93
  v_fmac_f32 v90, v64, v94
  v_fmac_f32 v91, v64, v95
  v_fma_f32 v92, v65, v92, v56
  v_fma_f32 v93, v65, v93, v57
  v_fma_f32 v94, v65, v94, v58
  v_fma_f32 v95, v65, v95, v59
  s_nop 1
  s_add_u32 m0, s62, s68
  s_nop 0
  buffer_load_dwordx4 v0, s[44:47], s56 offen lds
  s_add_u32 s56, s56, s59
  s_waitcnt lgkmcnt(8)
  v_mfma_f32_16x16x32_bf16 v[100:103], v[20:23], v[52:55], v[100:103]
  v_mul_f32 v116, v104, v71
  v_mul_f32 v117, v105, v71
  v_mul_f32 v118, v106, v71
  v_mul_f32 v119, v107, v71
  v_fmac_f32 v116, v67, v108
  v_fmac_f32 v117, v67, v109
  v_fmac_f32 v118, v67, v110
  v_fmac_f32 v119, v67, v111
  v_mfma_f32_16x16x32_bf16 v[96:99], v[20:23], v[48:51], v[96:99]
  v_mul_f32 v112, v104, v70
  v_mul_f32 v113, v105, v70
  v_mul_f32 v114, v106, v70
  v_mul_f32 v115, v107, v70
  v_fmac_f32 v112, v66, v108
  v_fmac_f32 v113, v66, v109
  v_fmac_f32 v114, v66, v110
  v_fmac_f32 v115, v66, v111
  v_mfma_f32_16x16x32_bf16 v[92:95], v[20:23], v[44:47], v[92:95]
  v_mul_f32 v56, v104, v69
  v_mul_f32 v57, v105, v69
  v_mul_f32 v58, v106, v69
  v_mul_f32 v59, v107, v69
  v_mul_f32 v104, v104, v68
  v_mul_f32 v105, v105, v68
  v_mul_f32 v106, v106, v68
  v_mul_f32 v107, v107, v68
  v_mfma_f32_16x16x32_bf16 v[88:91], v[20:23], v[40:43], v[88:91]
  v_fmac_f32 v104, v64, v108
  v_fmac_f32 v105, v64, v109
  v_fmac_f32 v106, v64, v110
  v_fmac_f32 v107, v64, v111
  v_fma_f32 v108, v65, v108, v56
  v_fma_f32 v109, v65, v109, v57
  v_fma_f32 v110, v65, v110, v58
  v_fma_f32 v111, v65, v111, v59
  s_nop 1
  s_add_u32 m0, s63, s68
  s_nop 0
  buffer_load_dwordx4 v1, s[48:51], s57 offen lds
  s_add_u32 s57, s57, s60
  s_waitcnt lgkmcnt(6)
  v_mfma_f32_16x16x32_bf16 v[116:119], v[24:27], v[52:55], v[116:119]
  v_mul_f32 v132, v120, v71
  v_mul_f32 v133, v121, v71
  v_mul_f32 v134, v122, v71
  v_mul_f32 v135, v123, v71
  v_fmac_f32 v132, v67, v124
  v_fmac_f32 v133, v67, v125
  v_fmac_f32 v134, v67, v126
  v_fmac_f32 v135, v67, v127
  v_mfma_f32_16x16x32_bf16 v[112:115], v[24:27], v[48:51], v[112:115]
  v_mul_f32 v128, v120, v70
  v_mul_f32 v129, v121, v70
  v_mul_f32 v130, v122, v70
  v_mul_f32 v131, v123, v70
  v_fmac_f32 v128, v66, v124
  v_fmac_f32 v129, v66, v125
  v_fmac_f32 v130, v66, v126
  v_fmac_f32 v131, v66, v127
  v_mfma_f32_16x16x32_bf16 v[108:111], v[24:27], v[44:47], v[108:111]
  v_mul_f32 v56, v120, v69
  v_mul_f32 v57, v121, v69
  v_mul_f32 v58, v122, v69
  v_mul_f32 v59, v123, v69
  v_mul_f32 v120, v120, v68
  v_mul_f32 v121, v121, v68
  v_mul_f32 v122, v122, v68
  v_mul_f32 v123, v123, v68
  v_mfma_f32_16x16x32_bf16 v[104:107], v[24:27], v[40:43], v[104:107]
  v_fmac_f32 v120, v64, v124
  v_fmac_f32 v121, v64, v125
  v_fmac_f32 v122, v64, v126
  v_fmac_f32 v123, v64, v127
  v_fma_f32 v124, v65, v124, v56
  v_fma_f32 v125, v65, v125, v57
  v_fma_f32 v126, v65, v126, v58
  v_fma_f32 v127, v65, v127, v59
  s_nop 1
  s_add_u32 m0, s64, s68
  s_nop 0
  buffer_load_dwordx4 v2, s[52:55], s58 offen lds
  s_add_u32 s58, s58, s61
  s_add_u32 s68, s68, 36864
  s_cmp_eq_u32 s68, 147456
  s_cselect_b32 s68, 0, s68
  s_waitcnt lgkmcnt(4)
  v_mfma_f32_16x16x32_bf16 v[132:135], v[28:31], v[52:55], v[132:135]
  v_mul_f32 v148, v136, v71
  v_mul_f32 v149, v137, v71
  v_mul_f32 v150, v138, v71
  v_mul_f32 v151, v139, v71
  v_fmac_f32 v148, v67, v140
  v_fmac_f32 v149, v67, v141
  v_fmac_f32 v150, v67, v142
  v_fmac_f32 v151, v67, v143
  v_mfma_f32_16x16x32_bf16 v[128:131], v[28:31], v[48:51], v[128:131]
  v_mul_f32 v144, v136, v70
  v_mul_f32 v145, v137, v70
  v_mul_f32 v146, v138, v70
  v_mul_f32 v147, v139, v70
  v_fmac_f32 v144, v66, v140
  v_fmac_f32 v145, v66, v141
  v_fmac_f32 v146, v66, v142
  v_fmac_f32 v147, v66, v143
  v_mfma_f32_16x16x32_bf16 v[124:127], v[28:31], v[44:47], v[124:127]
  v_mul_f32 v56, v136, v69
  v_mul_f32 v57, v137, v69
  v_mul_f32 v58, v138, v69
  v_mul_f32 v59, v139, v69
  v_mul_f32 v136, v136, v68
  v_mul_f32 v137, v137, v68
  v_mul_f32 v138, v138, v68
  v_mul_f32 v139, v139, v68
  v_mfma_f32_16x16x32_bf16 v[120:123], v[28:31], v[40:43], v[120:123]
  v_fmac_f32 v136, v64, v140
  v_fmac_f32 v137, v64, v141
  v_fmac_f32 v138, v64, v142
  v_fmac_f32 v139, v64, v143
  v_fma_f32 v140, v65, v140, v56
  v_fma_f32 v141, v65, v141, v57
  v_fma_f32 v142, v65, v142, v58
  v_fma_f32 v143, v65, v143, v59
  s_nop 1
  s_waitcnt lgkmcnt(2)
  v_mfma_f32_16x16x32_bf16 v[148:151], v[32:35], v[52:55], v[148:151]
  v_mul_f32 v164, v152, v71
  v_mul_f32 v165, v153, v71
  v_mul_f32 v166, v154, v71
  v_mul_f32 v167, v155, v71
  v_fmac_f32 v164, v67, v156
  v_fmac_f32 v165, v67, v157
  v_fmac_f32 v166, v67, v158
  v_fmac_f32 v167, v67, v159
  v_mfma_f32_16x16x32_bf16 v[144:147], v[32:35], v[48:51], v[144:147]
  v_mul_f32 v160, v152, v70
  v_mul_f32 v161, v153, v70
  v_mul_f32 v162, v154, v70
  v_mul_f32 v163, v155, v70
  v_fmac_f32 v160, v66, v156
  v_fmac_f32 v161, v66, v157
  v_fmac_f32 v162, v66, v158
  v_fmac_f32 v163, v66, v159
  v_mfma_f32_16x16x32_bf16 v[140:143], v[32:35], v[44:47], v[140:143]
  v_mul_f32 v56, v152, v69
  v_mul_f32 v57, v153, v69
  v_mul_f32 v58, v154, v69
  v_mul_f32 v59, v155, v69
  v_mul_f32 v152, v152, v68
  v_mul_f32 v153, v153, v68
  v_mul_f32 v154, v154, v68
  v_mul_f32 v155, v155, v68
  v_mfma_f32_16x16x32_bf16 v[136:139], v[32:35], v[40:43], v[136:139]
  v_fmac_f32 v152, v64, v156
  v_fmac_f32 v153, v64, v157
  v_fmac_f32 v154, v64, v158
  v_fmac_f32 v155, v64, v159
  v_fma_f32 v156, v65, v156, v56
  v_fma_f32 v157, v65, v157, v57
  v_fma_f32 v158, v65, v158, v58
  v_fma_f32 v159, v65, v159, v59
  s_nop 1
  s_waitcnt vmcnt(3)
  s_barrier
  ds_read_b128 v[56:59], v3 offset:36864
  ds_read_b128 v[60:63], v3 offset:37888
  ds_read_b128 v[64:67], v3 offset:38912
  ds_read_b128 v[68:71], v3 offset:39936
  ds_read_b64_tr_b16 v[16:17], v5 offset:53248
  ds_read_b64_tr_b16 v[18:19], v5 offset:54400
  ds_read_b64_tr_b16 v[20:21], v5 offset:63488
  ds_read_b64_tr_b16 v[22:23], v5 offset:64640
  ds_read_b64_tr_b16 v[24:25], v5 offset:53280
  ds_read_b64_tr_b16 v[26:27], v5 offset:54432
  ds_read_b64_tr_b16 v[28:29], v5 offset:63520
  ds_read_b64_tr_b16 v[30:31], v5 offset:64672
  ds_read_b64_tr_b16 v[32:33], v5 offset:53312
  ds_read_b64_tr_b16 v[34:35], v5 offset:54464
  s_waitcnt lgkmcnt(14)
  v_mfma_f32_16x16x32_bf16 v[164:167], v[36:39], v[52:55], v[164:167]
  v_mfma_f32_16x16x32_bf16 v[160:163], v[36:39], v[48:51], v[160:163]
  v_mfma_f32_16x16x32_bf16 v[156:159], v[36:39], v[44:47], v[156:159]
  v_mfma_f32_16x16x32_bf16 v[152:155], v[36:39], v[40:43], v[152:155]
  ds_read_b64_tr_b16 v[36:37], v5 offset:63552
  ds_read_b64_tr_b16 v[38:39], v5 offset:64704
  s_add_u32 m0, s62, s68
  s_nop 0
  buffer_load_dwordx4 v0, s[44:47], s56 offen lds
  s_add_u32 s56, s56, s59
  s_add_u32 m0, s63, s68
  s_nop 0
  buffer_load_dwordx4 v1, s[48:51], s57 offen lds
  s_add_u32 s57, s57, s60
  s_add_u32 m0, s64, s68
  s_nop 0
  buffer_load_dwordx4 v2, s[52:55], s58 offen lds
  s_add_u32 s58, s58, s61
  s_add_u32 s68, s68, 36864
  s_cmp_eq_u32 s68, 147456
  s_cselect_b32 s68, 0, s68
  s_waitcnt lgkmcnt(10)
  v_mfma_f32_16x16x32_bf16 v[72:75], v[16:19], v[56:59], v[72:75]
  v_mfma_f32_16x16x32_bf16 v[76:79], v[16:19], v[60:63], v[76:79]
  v_mfma_f32_16x16x32_bf16 v[80:83], v[16:19], v[64:67], v[80:83]
  v_mfma_f32_16x16x32_bf16 v[84:87], v[16:19], v[68:71], v[84:87]
  s_waitcnt vmcnt(3)
  s_barrier
  ds_read_b128 v[40:43], v4 offset:0
  ds_read_b128 v[44:47], v4 offset:1024
  ds_read_b128 v[48:51], v4 offset:2048
  ds_read_b128 v[52:55], v4 offset:3072
  ds_read_b64_tr_b16 v[16:17], v6 offset:16384
  ds_read_b64_tr_b16 v[18:19], v6 offset:17536
  s_waitcnt lgkmcnt(14)
  v_mfma_f32_16x16x32_bf16 v[88:91], v[20:23], v[56:59], v[88:91]
  v_mfma_f32_16x16x32_bf16 v[92:95], v[20:23], v[60:63], v[92:95]
  v_mfma_f32_16x16x32_bf16 v[96:99], v[20:23], v[64:67], v[96:99]
  v_mfma_f32_16x16x32_bf16 v[100:103], v[20:23], v[68:71], v[100:103]
  ds_read_b64_tr_b16 v[20:21], v6 offset:26624
  ds_read_b64_tr_b16 v[22:23], v6 offset:27776
  s_waitcnt lgkmcnt(14)
  v_mfma_f32_16x16x32_bf16 v[104:107], v[24:27], v[56:59], v[104:107]
  v_mfma_f32_16x16x32_bf16 v[108:111], v[24:27], v[60:63], v[108:111]
  v_mfma_f32_16x16x32_bf16 v[112:115], v[24:27], v[64:67], v[112:115]
  v_mfma_f32_16x16x32_bf16 v[116:119], v[24:27], v[68:71], v[116:119]
  ds_read_b64_tr_b16 v[24:25], v6 offset:16416
  ds_read_b64_tr_b16 v[26:27], v6 offset:17568
  s_waitcnt lgkmcnt(14)
  v_mfma_f32_16x16x32_bf16 v[120:123], v[28:31], v[56:59], v[120:123]
  v_mfma_f32_16x16x32_bf16 v[124:127], v[28:31], v[60:63], v[124:127]
  v_mfma_f32_16x16x32_bf16 v[128:131], v[28:31], v[64:67], v[128:131]
  v_mfma_f32_16x16x32_bf16 v[132:135], v[28:31], v[68:71], v[132:135]
  ds_read_b64_tr_b16 v[28:29], v6 offset:26656
  ds_read_b64_tr_b16 v[30:31], v6 offset:27808
  s_add_u32 m0, s62, s68
  s_nop 0
  buffer_load_dwordx4 v0, s[44:47], s56 offen lds
  s_add_u32 s56, s56, s59
  s_waitcnt lgkmcnt(14)
  v_mfma_f32_16x16x32_bf16 v[136:139], v[32:35], v[56:59], v[136:139]
  v_mfma_f32_16x16x32_bf16 v[140:143], v[32:35], v[60:63], v[140:143]
  v_mfma_f32_16x16x32_bf16 v[144:147], v[32:35], v[64:67], v[144:147]
  v_mfma_f32_16x16x32_bf16 v[148:151], v[32:35], v[68:71], v[148:151]
  ds_read_b64_tr_b16 v[32:33], v6 offset:16448
  ds_read_b64_tr_b16 v[34:35], v6 offset:17600
  s_add_u32 m0, s63, s68
  s_nop 0
  buffer_load_dwordx4 v1, s[48:51], s57 offen lds
  s_add_u32 s57, s57, s60
  s_waitcnt lgkmcnt(14)
  v_mfma_f32_16x16x32_bf16 v[152:155], v[36:39], v[56:59], v[152:155]
  v_mfma_f32_16x16x32_bf16 v[156:159], v[36:39], v[60:63], v[156:159]
  v_mfma_f32_16x16x32_bf16 v[160:163], v[36:39], v[64:67], v[160:163]
  v_mfma_f32_16x16x32_bf16 v[164:167], v[36:39], v[68:71], v[164:167]
  ds_read_b64_tr_b16 v[36:37], v6 offset:26688
  ds_read_b64_tr_b16 v[38:39], v6 offset:27840
  s_add_u32 m0, s64, s68
  s_nop 0
  buffer_load_dwordx4 v2, s[52:55], s58 offen lds
  s_add_u32 s58, s58, s61
  s_add_u32 s68, s68, 36864
  s_cmp_eq_u32 s68, 147456
  s_cselect_b32 s68, 0, s68
  v_swap_b32 v3, v4
  v_swap_b32 v5, v6
  s_mov_b32 s40, 6
.p2align 6
L_k5_loop:
  s_waitcnt lgkmcnt(10)
  v_mfma_f32_16x16x32_bf16 v[72:75], v[16:19], v[40:43], v[72:75]
  v_mfma_f32_16x16x32_bf16 v[76:79], v[16:19], v[44:47], v[76:79]
  v_mfma_f32_16x16x32_bf16 v[80:83], v[16:19], v[48:51], v[80:83]
  v_mfma_f32_16x16x32_bf16 v[84:87], v[16:19], v[52:55], v[84:87]
  s_waitcnt vmcnt(3)
  s_barrier
  ds_read_b128 v[56:59], v3 offset:36864
  ds_read_b128 v[60:63], v3 offset:37888
  ds_read_b128 v[64:67], v3 offset:38912
  ds_read_b128 v[68:71], v3 offset:39936
  ds_read_b64_tr_b16 v[16:17], v5 offset:53248
  ds_read_b64_tr_b16 v[18:19], v5 offset:54400
  s_waitcnt lgkmcnt(14)
  v_mfma_f32_16x16x32_bf16 v[88:91], v[20:23], v[40:43], v[88:91]
  v_mfma_f32_16x16x32_bf16 v[92:95], v[20:23], v[44:47], v[92:95]
  v_mfma_f32_16x16x32_bf16 v[96:99], v[20:23], v[48:51], v[96:99]
  v_mfma_f32_16x16x32_bf16 v[100:103], v[20:23], v[52:55], v[100:103]
  ds_read_b64_tr_b16 v[20:21], v5 offset:63488
  ds_read_b64_tr_b16 v[22:23], v5 offset:64640
  s_waitcnt lgkmcnt(14)
  v_mfma_f32_16x16x32_bf16 v[104:107], v[24:27], v[40:43], v[104:107]
  v_mfma_f32_16x16x32_bf16 v[108:111], v[24:27], v[44:47], v[108:111]
  v_mfma_f32_16x16x32_bf16 v[112:115], v[24:27], v[48:51], v[112:115]
  v_mfma_f32_16x16x32_bf16 v[116:119], v[24:27], v[52:55], v[116:119]
  ds_read_b64_tr_b16 v[24:25], v5 offset:53280
  ds_read_b64_tr_b16 v[26:27], v5 offset:54432
  s_waitcnt lgkmcnt(14)
  v_mfma_f32_16x16x32_bf16 v[120:123], v[28:31], v[40:43], v[120:123]
  v_mfma_f32_16x16x32_bf16 v[124:127], v[28:31], v[44:47], v[124:127]
  v_mfma_f32_16x16x32_bf16 v[128:131], v[28:31], v[48:51], v[128:131]
  v_mfma_f32_16x16x32_bf16 v[132:135], v[28:31], v[52:55], v[132:135]
  ds_read_b64_tr_b16 v[28:29], v5 offset:63520
  ds_read_b64_tr_b16 v[30:31], v5 offset:64672
  s_add_u32 m0, s62, s68
  s_nop 0
  buffer_load_dwordx4 v0, s[44:47], s56 offen lds
  s_add_u32 s56, s56, s59
  s_waitcnt lgkmcnt(14)
  v_mfma_f32_16x16x32_bf16 v[136:139], v[32:35], v[40:43], v[136:139]
  v_mfma_f32_16x16x32_bf16 v[140:143], v[32:35], v[44:47], v[140:143]
  v_mfma_f32_16x16x32_bf16 v[144:147], v[32:35], v[48:51], v[144:147]
  v_mfma_f32_16x16x32_bf16 v[148:151], v[32:35], v[52:55], v[148:151]
  ds_read_b64_tr_b16 v[32:33], v5 offset:53312
  ds_read_b64_tr_b16 v[34:35], v5 offset:54464
  s_add_u32 m0, s63, s68
  s_nop 0
  buffer_load_dwordx4 v1, s[48:51], s57 offen lds
  s_add_u32 s57, s57, s60
  s_waitcnt lgkmcnt(14)
  v_mfma_f32_16x16x32_bf16 v[152:155], v[36:39], v[40:43], v[152:155]
  v_mfma_f32_16x16x32_bf16 v[156:159], v[36:39], v[44:47], v[156:159]
  v_mfma_f32_16x16x32_bf16 v[160:163], v[36:39], v[48:51], v[160:163]
  v_mfma_f32_16x16x32_bf16 v[164:167], v[36:39], v[52:55], v[164:167]
  ds_read_b64_tr_b16 v[36:37], v5 offset:63552
  ds_read_b64_tr_b16 v[38:39], v5 offset:64704
  s_add_u32 m0, s64, s68
  s_nop 0
  buffer_load_dwordx4 v2, s[52:55], s58 offen lds
  s_add_u32 s58, s58, s61
  s_add_u32 s68, s68, 36864
  s_cmp_eq_u32 s68, 147456
  s_cselect_b32 s68, 0, s68
  s_waitcnt lgkmcnt(10)
  v_mfma_f32_16x16x32_bf16 v[72:75], v[16:19], v[56:59], v[72:75]
  v_mfma_f32_16x16x32_bf16 v[76:79], v[16:19], v[60:63], v[76:79]
  v_mfma_f32_16x16x32_bf16 v[80:83], v[16:19], v[64:67], v[80:83]
  v_mfma_f32_16x16x32_bf16 v[84:87], v[16:19], v[68:71], v[84:87]
  s_waitcnt vmcnt(3)
  s_barrier
  ds_read_b128 v[40:43], v4 offset:0
  ds_read_b128 v[44:47], v4 offset:1024
  ds_read_b128 v[48:51], v4 offset:2048
  ds_read_b128 v[52:55], v4 offset:3072
  ds_read_b64_tr_b16 v[16:17], v6 offset:16384
  ds_read_b64_tr_b16 v[18:19], v6 offset:17536
  s_waitcnt lgkmcnt(14)
  v_mfma_f32_16x16x32_bf16 v[88:91], v[20:23], v[56:59], v[88:91]
  v_mfma_f32_16x16x32_bf16 v[92:95], v[20:23], v[60:63], v[92:95]
  v_mfma_f32_16x16x32_bf16 v[96:99], v[20:23], v[64:67], v[96:99]
  v_mfma_f32_16x16x32_bf16 v[100:103], v[20:23], v[68:71], v[100:103]
  ds_read_b64_tr_b16 v[20:21], v6 offset:26624
  ds_read_b64_tr_b16 v[22:23], v6 offset:27776
  s_waitcnt lgkmcnt(14)
  v_mfma_f32_16x16x32_bf16 v[104:107], v[24:27], v[56:59], v[104:107]
  v_mfma_f32_16x16x32_bf16 v[108:111], v[24:27], v[60:63], v[108:111]
  v_mfma_f32_16x16x32_bf16 v[112:115], v[24:27], v[64:67], v[112:115]
  v_mfma_f32_16x16x32_bf16 v[116:119], v[24:27], v[68:71], v[116:119]
  ds_read_b64_tr_b16 v[24:25], v6 offset:16416
  ds_read_b64_tr_b16 v[26:27], v6 offset:17568
  s_waitcnt lgkmcnt(14)
  v_mfma_f32_16x16x32_bf16 v[120:123], v[28:31], v[56:59], v[120:123]
  v_mfma_f32_16x16x32_bf16 v[124:127], v[28:31], v[60:63], v[124:127]
  v_mfma_f32_16x16x32_bf16 v[128:131], v[28:31], v[64:67], v[128:131]
  v_mfma_f32_16x16x32_bf16 v[132:135], v[28:31], v[68:71], v[132:135]
  ds_read_b64_tr_b16 v[28:29], v6 offset:26656
  ds_read_b64_tr_b16 v[30:31], v6 offset:27808
  s_add_u32 m0, s62, s68
  s_nop 0
  buffer_load_dwordx4 v0, s[44:47], s56 offen lds
  s_add_u32 s56, s56, s59
  s_waitcnt lgkmcnt(14)
  v_mfma_f32_16x16x32_bf16 v[136:139], v[32:35], v[56:59], v[136:139]
  v_mfma_f32_16x16x32_bf16 v[140:143], v[32:35], v[60:63], v[140:143]
  v_mfma_f32_16x16x32_bf16 v[144:147], v[32:35], v[64:67], v[144:147]
  v_mfma_f32_16x16x32_bf16 v[148:151], v[32:35], v[68:71], v[148:151]
  ds_read_b64_tr_b16 v[32:33], v6 offset:16448
  ds_read_b64_tr_b16 v[34:35], v6 offset:17600
  s_add_u32 m0, s63, s68
  s_nop 0
  buffer_load_dwordx4 v1, s[48:51], s57 offen lds
  s_add_u32 s57, s57, s60
  s_waitcnt lgkmcnt(14)
  v_mfma_f32_16x16x32_bf16 v[152:155], v[36:39], v[56:59], v[152:155]
  v_mfma_f32_16x16x32_bf16 v[156:159], v[36:39], v[60:63], v[156:159]
  v_mfma_f32_16x16x32_bf16 v[160:163], v[36:39], v[64:67], v[160:163]
  v_mfma_f32_16x16x32_bf16 v[164:167], v[36:39], v[68:71], v[164:167]
  ds_read_b64_tr_b16 v[36:37], v6 offset:26688
  ds_read_b64_tr_b16 v[38:39], v6 offset:27840
  s_add_u32 m0, s64, s68
  s_nop 0
  buffer_load_dwordx4 v2, s[52:55], s58 offen lds
  s_add_u32 s58, s58, s61
  s_add_u32 s68, s68, 36864
  s_cmp_eq_u32 s68, 147456
  s_cselect_b32 s68, 0, s68
  v_swap_b32 v3, v4
  v_swap_b32 v5, v6
  s_sub_u32 s40, s40, 1
  s_cmp_lg_u32 s40, 0
  s_cbranch_scc1 L_k5_loop
  s_waitcnt lgkmcnt(10)
  v_mfma_f32_16x16x32_bf16 v[72:75], v[16:19], v[40:43], v[72:75]
  v_mfma_f32_16x16x32_bf16 v[76:79], v[16:19], v[44:47], v[76:79]
  v_mfma_f32_16x16x32_bf16 v[80:83], v[16:19], v[48:51], v[80:83]
  v_mfma_f32_16x16x32_bf16 v[84:87], v[16:19], v[52:55], v[84:87]
  s_waitcnt vmcnt(3)
  s_barrier
  ds_read_b128 v[56:59], v3 offset:36864
  ds_read_b128 v[60:63], v3 offset:37888
  ds_read_b128 v[64:67], v3 offset:38912
  ds_read_b128 v[68:71], v3 offset:39936
  ds_read_b64_tr_b16 v[16:17], v5 offset:53248
  ds_read_b64_tr_b16 v[18:19], v5 offset:54400
  s_waitcnt lgkmcnt(14)
  v_mfma_f32_16x16x32_bf16 v[88:91], v[20:23], v[40:43], v[88:91]
  v_mfma_f32_16x16x32_bf16 v[92:95], v[20:23], v[44:47], v[92:95]
  v_mfma_f32_16x16x32_bf16 v[96:99], v[20:23], v[48:51], v[96:99]
  v_mfma_f32_16x16x32_bf16 v[100:103], v[20:23], v[52:55], v[100:103]
  ds_read_b64_tr_b16 v[20:21], v5 offset:63488
  ds_read_b64_tr_b16 v[22:23], v5 offset:64640
  s_waitcnt lgkmcnt(14)
  v_mfma_f32_16x16x32_bf16 v[104:107], v[24:27], v[40:43], v[104:107]
  v_mfma_f32_16x16x32_bf16 v[108:111], v[24:27], v[44:47], v[108:111]
  v_mfma_f32_16x16x32_bf16 v[112:115], v[24:27], v[48:51], v[112:115]
  v_mfma_f32_16x16x32_bf16 v[116:119], v[24:27], v[52:55], v[116:119]
  ds_read_b64_tr_b16 v[24:25], v5 offset:53280
  ds_read_b64_tr_b16 v[26:27], v5 offset:54432
  s_waitcnt lgkmcnt(14)
  v_mfma_f32_16x16x32_bf16 v[120:123], v[28:31], v[40:43], v[120:123]
  v_mfma_f32_16x16x32_bf16 v[124:127], v[28:31], v[44:47], v[124:127]
  v_mfma_f32_16x16x32_bf16 v[128:131], v[28:31], v[48:51], v[128:131]
  v_mfma_f32_16x16x32_bf16 v[132:135], v[28:31], v[52:55], v[132:135]
  ds_read_b64_tr_b16 v[28:29], v5 offset:63520
  ds_read_b64_tr_b16 v[30:31], v5 offset:64672
  s_add_u32 m0, s62, s68
  s_nop 0
  buffer_load_dwordx4 v0, s[44:47], s56 offen lds
  s_add_u32 s56, s56, s59
  s_waitcnt lgkmcnt(14)
  v_mfma_f32_16x16x32_bf16 v[136:139], v[32:35], v[40:43], v[136:139]
  v_mfma_f32_16x16x32_bf16 v[140:143], v[32:35], v[44:47], v[140:143]
  v_mfma_f32_16x16x32_bf16 v[144:147], v[32:35], v[48:51], v[144:147]
  v_mfma_f32_16x16x32_bf16 v[148:151], v[32:35], v[52:55], v[148:151]
  ds_read_b64_tr_b16 v[32:33], v5 offset:53312
  ds_read_b64_tr_b16 v[34:35], v5 offset:54464
  s_add_u32 m0, s63, s68
  s_nop 0
  buffer_load_dwordx4 v1, s[48:51], s57 offen lds
  s_add_u32 s57, s57, s60
  s_waitcnt lgkmcnt(14)
  v_mfma_f32_16x16x32_bf16 v[152:155], v[36:39], v[40:43], v[152:155]
  v_mfma_f32_16x16x32_bf16 v[156:159], v[36:39], v[44:47], v[156:159]
  v_mfma_f32_16x16x32_bf16 v[160:163], v[36:39], v[48:51], v[160:163]
  v_mfma_f32_16x16x32_bf16 v[164:167], v[36:39], v[52:55], v[164:167]
  ds_read_b64_tr_b16 v[36:37], v5 offset:63552
  ds_read_b64_tr_b16 v[38:39], v5 offset:64704
  s_add_u32 m0, s64, s68
  s_nop 0
  buffer_load_dwordx4 v2, s[52:55], s58 offen lds
  s_add_u32 s58, s58, s61
  s_add_u32 s68, s68, 36864
  s_cmp_eq_u32 s68, 147456
  s_cselect_b32 s68, 0, s68
  s_waitcnt lgkmcnt(10)
  v_mfma_f32_16x16x32_bf16 v[72:75], v[16:19], v[56:59], v[72:75]
  v_mfma_f32_16x16x32_bf16 v[76:79], v[16:19], v[60:63], v[76:79]
  v_mfma_f32_16x16x32_bf16 v[80:83], v[16:19], v[64:67], v[80:83]
  v_mfma_f32_16x16x32_bf16 v[84:87], v[16:19], v[68:71], v[84:87]
  s_waitcnt vmcnt(0)
  s_barrier
  ds_read_b128 v[40:43], v4 offset:0
  ds_read_b128 v[44:47], v4 offset:1024
  ds_read_b128 v[48:51], v4 offset:2048
  ds_read_b128 v[52:55], v4 offset:3072
  ds_read_b64_tr_b16 v[16:17], v6 offset:16384
  ds_read_b64_tr_b16 v[18:19], v6 offset:17536
  s_waitcnt lgkmcnt(14)
  v_mfma_f32_16x16x32_bf16 v[88:91], v[20:23], v[56:59], v[88:91]
  v_mfma_f32_16x16x32_bf16 v[92:95], v[20:23], v[60:63], v[92:95]
  v_mfma_f32_16x16x32_bf16 v[96:99], v[20:23], v[64:67], v[96:99]
  v_mfma_f32_16x16x32_bf16 v[100:103], v[20:23], v[68:71], v[100:103]
  ds_read_b64_tr_b16 v[20:21], v6 offset:26624
  ds_read_b64_tr_b16 v[22:23], v6 offset:27776
  s_waitcnt lgkmcnt(14)
  v_mfma_f32_16x16x32_bf16 v[104:107], v[24:27], v[56:59], v[104:107]
  v_mfma_f32_16x16x32_bf16 v[108:111], v[24:27], v[60:63], v[108:111]
  v_mfma_f32_16x16x32_bf16 v[112:115], v[24:27], v[64:67], v[112:115]
  v_mfma_f32_16x16x32_bf16 v[116:119], v[24:27], v[68:71], v[116:119]
  ds_read_b64_tr_b16 v[24:25], v6 offset:16416
  ds_read_b64_tr_b16 v[26:27], v6 offset:17568
  s_waitcnt lgkmcnt(14)
  v_mfma_f32_16x16x32_bf16 v[120:123], v[28:31], v[56:59], v[120:123]
  v_mfma_f32_16x16x32_bf16 v[124:127], v[28:31], v[60:63], v[124:127]
  v_mfma_f32_16x16x32_bf16 v[128:131], v[28:31], v[64:67], v[128:131]
  v_mfma_f32_16x16x32_bf16 v[132:135], v[28:31], v[68:71], v[132:135]
  ds_read_b64_tr_b16 v[28:29], v6 offset:26656
  ds_read_b64_tr_b16 v[30:31], v6 offset:27808
  s_waitcnt lgkmcnt(14)
  v_mfma_f32_16x16x32_bf16 v[136:139], v[32:35], v[56:59], v[136:139]
  v_mfma_f32_16x16x32_bf16 v[140:143], v[32:35], v[60:63], v[140:143]
  v_mfma_f32_16x16x32_bf16 v[144:147], v[32:35], v[64:67], v[144:147]
  v_mfma_f32_16x16x32_bf16 v[148:151], v[32:35], v[68:71], v[148:151]
  ds_read_b64_tr_b16 v[32:33], v6 offset:16448
  ds_read_b64_tr_b16 v[34:35], v6 offset:17600
  s_waitcnt lgkmcnt(14)
  v_mfma_f32_16x16x32_bf16 v[152:155], v[36:39], v[56:59], v[152:155]
  v_mfma_f32_16x16x32_bf16 v[156:159], v[36:39], v[60:63], v[156:159]
  v_mfma_f32_16x16x32_bf16 v[160:163], v[36:39], v[64:67], v[160:163]
  v_mfma_f32_16x16x32_bf16 v[164:167], v[36:39], v[68:71], v[164:167]
  ds_read_b64_tr_b16 v[36:37], v6 offset:26688
  ds_read_b64_tr_b16 v[38:39], v6 offset:27840
  v_swap_b32 v3, v4
  v_swap_b32 v5, v6
  s_waitcnt lgkmcnt(10)
  v_mfma_f32_16x16x32_bf16 v[72:75], v[16:19], v[40:43], v[72:75]
  v_mfma_f32_16x16x32_bf16 v[76:79], v[16:19], v[44:47], v[76:79]
  v_mfma_f32_16x16x32_bf16 v[80:83], v[16:19], v[48:51], v[80:83]
  v_mfma_f32_16x16x32_bf16 v[84:87], v[16:19], v[52:55], v[84:87]
  ds_read_b128 v[56:59], v3 offset:36864
  ds_read_b128 v[60:63], v3 offset:37888
  ds_read_b128 v[64:67], v3 offset:38912
  ds_read_b128 v[68:71], v3 offset:39936
  ds_read_b64_tr_b16 v[16:17], v5 offset:53248
  ds_read_b64_tr_b16 v[18:19], v5 offset:54400
  s_waitcnt lgkmcnt(14)
  v_mfma_f32_16x16x32_bf16 v[88:91], v[20:23], v[40:43], v[88:91]
  v_mfma_f32_16x16x32_bf16 v[92:95], v[20:23], v[44:47], v[92:95]
  v_mfma_f32_16x16x32_bf16 v[96:99], v[20:23], v[48:51], v[96:99]
  v_mfma_f32_16x16x32_bf16 v[100:103], v[20:23], v[52:55], v[100:103]
  ds_read_b64_tr_b16 v[20:21], v5 offset:63488
  ds_read_b64_tr_b16 v[22:23], v5 offset:64640
  s_waitcnt lgkmcnt(14)
  v_mfma_f32_16x16x32_bf16 v[104:107], v[24:27], v[40:43], v[104:107]
  v_mfma_f32_16x16x32_bf16 v[108:111], v[24:27], v[44:47], v[108:111]
  v_mfma_f32_16x16x32_bf16 v[112:115], v[24:27], v[48:51], v[112:115]
  v_mfma_f32_16x16x32_bf16 v[116:119], v[24:27], v[52:55], v[116:119]
  ds_read_b64_tr_b16 v[24:25], v5 offset:53280
  ds_read_b64_tr_b16 v[26:27], v5 offset:54432
  s_waitcnt lgkmcnt(14)
  v_mfma_f32_16x16x32_bf16 v[120:123], v[28:31], v[40:43], v[120:123]
  v_mfma_f32_16x16x32_bf16 v[124:127], v[28:31], v[44:47], v[124:127]
  v_mfma_f32_16x16x32_bf16 v[128:131], v[28:31], v[48:51], v[128:131]
  v_mfma_f32_16x16x32_bf16 v[132:135], v[28:31], v[52:55], v[132:135]
  ds_read_b64_tr_b16 v[28:29], v5 offset:63520
  ds_read_b64_tr_b16 v[30:31], v5 offset:64672
  s_waitcnt lgkmcnt(14)
  v_mfma_f32_16x16x32_bf16 v[136:139], v[32:35], v[40:43], v[136:139]
  v_mfma_f32_16x16x32_bf16 v[140:143], v[32:35], v[44:47], v[140:143]
  v_mfma_f32_16x16x32_bf16 v[144:147], v[32:35], v[48:51], v[144:147]
  v_mfma_f32_16x16x32_bf16 v[148:151], v[32:35], v[52:55], v[148:151]
  ds_read_b64_tr_b16 v[32:33], v5 offset:53312
  ds_read_b64_tr_b16 v[34:35], v5 offset:54464
  s_waitcnt lgkmcnt(14)
  v_mfma_f32_16x16x32_bf16 v[152:155], v[36:39], v[40:43], v[152:155]
  v_mfma_f32_16x16x32_bf16 v[156:159], v[36:39], v[44:47], v[156:159]
  v_mfma_f32_16x16x32_bf16 v[160:163], v[36:39], v[48:51], v[160:163]
  v_mfma_f32_16x16x32_bf16 v[164:167], v[36:39], v[52:55], v[164:167]
  ds_read_b64_tr_b16 v[36:37], v5 offset:63552
  ds_read_b64_tr_b16 v[38:39], v5 offset:64704
  s_waitcnt lgkmcnt(10)
  v_mfma_f32_16x16x32_bf16 v[72:75], v[16:19], v[56:59], v[72:75]
  v_mfma_f32_16x16x32_bf16 v[76:79], v[16:19], v[60:63], v[76:79]
  v_mfma_f32_16x16x32_bf16 v[80:83], v[16:19], v[64:67], v[80:83]
  v_mfma_f32_16x16x32_bf16 v[84:87], v[16:19], v[68:71], v[84:87]
  s_waitcnt lgkmcnt(8)
  v_mfma_f32_16x16x32_bf16 v[88:91], v[20:23], v[56:59], v[88:91]
  v_mfma_f32_16x16x32_bf16 v[92:95], v[20:23], v[60:63], v[92:95]
  v_mfma_f32_16x16x32_bf16 v[96:99], v[20:23], v[64:67], v[96:99]
  v_mfma_f32_16x16x32_bf16 v[100:103], v[20:23], v[68:71], v[100:103]
  s_waitcnt lgkmcnt(6)
  v_mfma_f32_16x16x32_bf16 v[104:107], v[24:27], v[56:59], v[104:107]
  v_mfma_f32_16x16x32_bf16 v[108:111], v[24:27], v[60:63], v[108:111]
  v_mfma_f32_16x16x32_bf16 v[112:115], v[24:27], v[64:67], v[112:115]
  v_mfma_f32_16x16x32_bf16 v[116:119], v[24:27], v[68:71], v[116:119]
  s_waitcnt lgkmcnt(4)
  v_mfma_f32_16x16x32_bf16 v[120:123], v[28:31], v[56:59], v[120:123]
  v_mfma_f32_16x16x32_bf16 v[124:127], v[28:31], v[60:63], v[124:127]
  v_mfma_f32_16x16x32_bf16 v[128:131], v[28:31], v[64:67], v[128:131]
  v_mfma_f32_16x16x32_bf16 v[132:135], v[28:31], v[68:71], v[132:135]
  s_waitcnt lgkmcnt(2)
  v_mfma_f32_16x16x32_bf16 v[136:139], v[32:35], v[56:59], v[136:139]
  v_mfma_f32_16x16x32_bf16 v[140:143], v[32:35], v[60:63], v[140:143]
  v_mfma_f32_16x16x32_bf16 v[144:147], v[32:35], v[64:67], v[144:147]
  v_mfma_f32_16x16x32_bf16 v[148:151], v[32:35], v[68:71], v[148:151]
  s_waitcnt lgkmcnt(0)
  v_mfma_f32_16x16x32_bf16 v[152:155], v[36:39], v[56:59], v[152:155]
  v_mfma_f32_16x16x32_bf16 v[156:159], v[36:39], v[60:63], v[156:159]
  v_mfma_f32_16x16x32_bf16 v[160:163], v[36:39], v[64:67], v[160:163]
  v_mfma_f32_16x16x32_bf16 v[164:167], v[36:39], v[68:71], v[164:167]
  s_nop 7
  s_add_u32 s28, s20, 48930816
  s_addc_u32 s29, s21, 0
  s_mov_b32 s30, 16384
  s_mov_b32 s31, 0x20000
  s_cmp_ge_u32 s2, 64
  s_cbranch_scc1 L_k5_nf
  s_cmp_lg_u32 s3, 0
  s_cbranch_scc1 L_k5_nf
  v_mov_b32 v16, 0
  v_mov_b32 v17, 0
  v_mov_b32 v18, 0
  v_mov_b32 v19, 0
  s_lshl_b32 s40, s2, 8
  s_mov_b64 exec, 1
  buffer_store_dwordx4 v[16:19], v16, s[28:31], s40 offen sc1
  s_mov_b64 exec, -1
  s_nop 1
L_k5_nf:
  s_add_u32 s28, s20, 11182080
  s_addc_u32 s29, s21, 0
  s_mov_b32 s30, 18874368
  s_mov_b32 s31, 0x20000
  s_lshl_b32 s41, s23, 3
  s_lshl_b32 s42, s24, 1
  s_add_u32 s41, s41, s42
  s_lshl_b32 s41, s41, 12
  s_mul_i32 s42, s22, 9
  s_mul_i32 s43, s25, 3
  s_add_u32 s42, s42, s43
  s_add_u32 s43, s42, 0
  s_lshr_b32 s44, s43, 2
  s_lshl_b32 s44, s44, 18
  s_and_b32 s43, s43, 3
  s_lshl_b32 s43, s43, 10
  s_add_u32 s44, s44, s43
  s_add_u32 s44, s44, s41
  s_add_u32 s45, s44, 4096
  v_mul_f32 v16, v8, v72
  v_mul_f32 v17, v8, v73
  v_mul_f32 v18, v8, v74
  v_mul_f32 v19, v8, v75
  v_exp_f32 v16, v16
  v_exp_f32 v17, v17
  v_exp_f32 v18, v18
  v_exp_f32 v19, v19
  v_mul_f32 v20, v72, v88
  v_mul_f32 v21, v73, v89
  v_mul_f32 v22, v74, v90
  v_mul_f32 v23, v75, v91
  v_add_f32 v16, 1.0, v16
  v_add_f32 v17, 1.0, v17
  v_add_f32 v18, 1.0, v18
  v_add_f32 v19, 1.0, v19
  v_rcp_f32 v16, v16
  v_rcp_f32 v17, v17
  v_rcp_f32 v18, v18
  v_rcp_f32 v19, v19
  v_mul_f32 v20, v12, v20
  v_mul_f32 v21, v12, v21
  v_mul_f32 v22, v12, v22
  v_mul_f32 v23, v12, v23
  v_mul_f32 v20, v20, v16
  v_mul_f32 v21, v21, v17
  v_mul_f32 v22, v22, v18
  v_mul_f32 v23, v23, v19
  v_cvt_pk_bf16_f32 v48, v20, v21
  v_cvt_pk_bf16_f32 v49, v22, v23
  v_mul_f32 v24, v9, v76
  v_mul_f32 v25, v9, v77
  v_mul_f32 v26, v9, v78
  v_mul_f32 v27, v9, v79
  v_exp_f32 v24, v24
  v_exp_f32 v25, v25
  v_exp_f32 v26, v26
  v_exp_f32 v27, v27
  v_mul_f32 v28, v76, v92
  v_mul_f32 v29, v77, v93
  v_mul_f32 v30, v78, v94
  v_mul_f32 v31, v79, v95
  v_add_f32 v24, 1.0, v24
  v_add_f32 v25, 1.0, v25
  v_add_f32 v26, 1.0, v26
  v_add_f32 v27, 1.0, v27
  v_rcp_f32 v24, v24
  v_rcp_f32 v25, v25
  v_rcp_f32 v26, v26
  v_rcp_f32 v27, v27
  v_mul_f32 v28, v13, v28
  v_mul_f32 v29, v13, v29
  v_mul_f32 v30, v13, v30
  v_mul_f32 v31, v13, v31
  v_mul_f32 v28, v28, v24
  v_mul_f32 v29, v29, v25
  v_mul_f32 v30, v30, v26
  v_mul_f32 v31, v31, v27
  v_cvt_pk_bf16_f32 v50, v28, v29
  v_cvt_pk_bf16_f32 v51, v30, v31
  s_nop 1
  v_permlane16_swap_b32 v48, v50
  v_permlane16_swap_b32 v49, v51
  buffer_store_dwordx4 v[48:51], v7, s[28:31], s44 offen sc1
  v_mul_f32 v16, v10, v80
  v_mul_f32 v17, v10, v81
  v_mul_f32 v18, v10, v82
  v_mul_f32 v19, v10, v83
  v_exp_f32 v16, v16
  v_exp_f32 v17, v17
  v_exp_f32 v18, v18
  v_exp_f32 v19, v19
  v_mul_f32 v20, v80, v96
  v_mul_f32 v21, v81, v97
  v_mul_f32 v22, v82, v98
  v_mul_f32 v23, v83, v99
  v_add_f32 v16, 1.0, v16
  v_add_f32 v17, 1.0, v17
  v_add_f32 v18, 1.0, v18
  v_add_f32 v19, 1.0, v19
  v_rcp_f32 v16, v16
  v_rcp_f32 v17, v17
  v_rcp_f32 v18, v18
  v_rcp_f32 v19, v19
  v_mul_f32 v20, v14, v20
  v_mul_f32 v21, v14, v21
  v_mul_f32 v22, v14, v22
  v_mul_f32 v23, v14, v23
  v_mul_f32 v20, v20, v16
  v_mul_f32 v21, v21, v17
  v_mul_f32 v22, v22, v18
  v_mul_f32 v23, v23, v19
  v_cvt_pk_bf16_f32 v52, v20, v21
  v_cvt_pk_bf16_f32 v53, v22, v23
  v_mul_f32 v24, v11, v84
  v_mul_f32 v25, v11, v85
  v_mul_f32 v26, v11, v86
  v_mul_f32 v27, v11, v87
  v_exp_f32 v24, v24
  v_exp_f32 v25, v25
  v_exp_f32 v26, v26
  v_exp_f32 v27, v27
  v_mul_f32 v28, v84, v100
  v_mul_f32 v29, v85, v101
  v_mul_f32 v30, v86, v102
  v_mul_f32 v31, v87, v103
  v_add_f32 v24, 1.0, v24
  v_add_f32 v25, 1.0, v25
  v_add_f32 v26, 1.0, v26
  v_add_f32 v27, 1.0, v27
  v_rcp_f32 v24, v24
  v_rcp_f32 v25, v25
  v_rcp_f32 v26, v26
  v_rcp_f32 v27, v27
  v_mul_f32 v28, v15, v28
  v_mul_f32 v29, v15, v29
  v_mul_f32 v30, v15, v30
  v_mul_f32 v31, v15, v31
  v_mul_f32 v28, v28, v24
  v_mul_f32 v29, v29, v25
  v_mul_f32 v30, v30, v26
  v_mul_f32 v31, v31, v27
  v_cvt_pk_bf16_f32 v54, v28, v29
  v_cvt_pk_bf16_f32 v55, v30, v31
  s_nop 1
  v_permlane16_swap_b32 v52, v54
  v_permlane16_swap_b32 v53, v55
  buffer_store_dwordx4 v[52:55], v7, s[28:31], s45 offen sc1
  s_add_u32 s43, s42, 1
  s_lshr_b32 s44, s43, 2
  s_lshl_b32 s44, s44, 18
  s_and_b32 s43, s43, 3
  s_lshl_b32 s43, s43, 10
  s_add_u32 s44, s44, s43
  s_add_u32 s44, s44, s41
  s_add_u32 s45, s44, 4096
  v_mul_f32 v16, v8, v104
  v_mul_f32 v17, v8, v105
  v_mul_f32 v18, v8, v106
  v_mul_f32 v19, v8, v107
  v_exp_f32 v16, v16
  v_exp_f32 v17, v17
  v_exp_f32 v18, v18
  v_exp_f32 v19, v19
  v_mul_f32 v20, v104, v120
  v_mul_f32 v21, v105, v121
  v_mul_f32 v22, v106, v122
  v_mul_f32 v23, v107, v123
  v_add_f32 v16, 1.0, v16
  v_add_f32 v17, 1.0, v17
  v_add_f32 v18, 1.0, v18
  v_add_f32 v19, 1.0, v19
  v_rcp_f32 v16, v16
  v_rcp_f32 v17, v17
  v_rcp_f32 v18, v18
  v_rcp_f32 v19, v19
  v_mul_f32 v20, v12, v20
  v_mul_f32 v21, v12, v21
  v_mul_f32 v22, v12, v22
  v_mul_f32 v23, v12, v23
  v_mul_f32 v20, v20, v16
  v_mul_f32 v21, v21, v17
  v_mul_f32 v22, v22, v18
  v_mul_f32 v23, v23, v19
  v_cvt_pk_bf16_f32 v56, v20, v21
  v_cvt_pk_bf16_f32 v57, v22, v23
  v_mul_f32 v24, v9, v108
  v_mul_f32 v25, v9, v109
  v_mul_f32 v26, v9, v110
  v_mul_f32 v27, v9, v111
  v_exp_f32 v24, v24
  v_exp_f32 v25, v25
  v_exp_f32 v26, v26
  v_exp_f32 v27, v27
  v_mul_f32 v28, v108, v124
  v_mul_f32 v29, v109, v125
  v_mul_f32 v30, v110, v126
  v_mul_f32 v31, v111, v127
  v_add_f32 v24, 1.0, v24
  v_add_f32 v25, 1.0, v25
  v_add_f32 v26, 1.0, v26
  v_add_f32 v27, 1.0, v27
  v_rcp_f32 v24, v24
  v_rcp_f32 v25, v25
  v_rcp_f32 v26, v26
  v_rcp_f32 v27, v27
  v_mul_f32 v28, v13, v28
  v_mul_f32 v29, v13, v29
  v_mul_f32 v30, v13, v30
  v_mul_f32 v31, v13, v31
  v_mul_f32 v28, v28, v24
  v_mul_f32 v29, v29, v25
  v_mul_f32 v30, v30, v26
  v_mul_f32 v31, v31, v27
  v_cvt_pk_bf16_f32 v58, v28, v29
  v_cvt_pk_bf16_f32 v59, v30, v31
  s_nop 1
  v_permlane16_swap_b32 v56, v58
  v_permlane16_swap_b32 v57, v59
  buffer_store_dwordx4 v[56:59], v7, s[28:31], s44 offen sc1
  v_mul_f32 v16, v10, v112
  v_mul_f32 v17, v10, v113
  v_mul_f32 v18, v10, v114
  v_mul_f32 v19, v10, v115
  v_exp_f32 v16, v16
  v_exp_f32 v17, v17
  v_exp_f32 v18, v18
  v_exp_f32 v19, v19
  v_mul_f32 v20, v112, v128
  v_mul_f32 v21, v113, v129
  v_mul_f32 v22, v114, v130
  v_mul_f32 v23, v115, v131
  v_add_f32 v16, 1.0, v16
  v_add_f32 v17, 1.0, v17
  v_add_f32 v18, 1.0, v18
  v_add_f32 v19, 1.0, v19
  v_rcp_f32 v16, v16
  v_rcp_f32 v17, v17
  v_rcp_f32 v18, v18
  v_rcp_f32 v19, v19
  v_mul_f32 v20, v14, v20
  v_mul_f32 v21, v14, v21
  v_mul_f32 v22, v14, v22
  v_mul_f32 v23, v14, v23
  v_mul_f32 v20, v20, v16
  v_mul_f32 v21, v21, v17
  v_mul_f32 v22, v22, v18
  v_mul_f32 v23, v23, v19
  v_cvt_pk_bf16_f32 v60, v20, v21
  v_cvt_pk_bf16_f32 v61, v22, v23
  v_mul_f32 v24, v11, v116
  v_mul_f32 v25, v11, v117
  v_mul_f32 v26, v11, v118
  v_mul_f32 v27, v11, v119
  v_exp_f32 v24, v24
  v_exp_f32 v25, v25
  v_exp_f32 v26, v26
  v_exp_f32 v27, v27
  v_mul_f32 v28, v116, v132
  v_mul_f32 v29, v117, v133
  v_mul_f32 v30, v118, v134
  v_mul_f32 v31, v119, v135
  v_add_f32 v24, 1.0, v24
  v_add_f32 v25, 1.0, v25
  v_add_f32 v26, 1.0, v26
  v_add_f32 v27, 1.0, v27
  v_rcp_f32 v24, v24
  v_rcp_f32 v25, v25
  v_rcp_f32 v26, v26
  v_rcp_f32 v27, v27
  v_mul_f32 v28, v15, v28
  v_mul_f32 v29, v15, v29
  v_mul_f32 v30, v15, v30
  v_mul_f32 v31, v15, v31
  v_mul_f32 v28, v28, v24
  v_mul_f32 v29, v29, v25
  v_mul_f32 v30, v30, v26
  v_mul_f32 v31, v31, v27
  v_cvt_pk_bf16_f32 v62, v28, v29
  v_cvt_pk_bf16_f32 v63, v30, v31
  s_nop 1
  v_permlane16_swap_b32 v60, v62
  v_permlane16_swap_b32 v61, v63
  buffer_store_dwordx4 v[60:63], v7, s[28:31], s45 offen sc1
  s_add_u32 s43, s42, 2
  s_lshr_b32 s44, s43, 2
  s_lshl_b32 s44, s44, 18
  s_and_b32 s43, s43, 3
  s_lshl_b32 s43, s43, 10
  s_add_u32 s44, s44, s43
  s_add_u32 s44, s44, s41
  s_add_u32 s45, s44, 4096
  v_mul_f32 v16, v8, v136
  v_mul_f32 v17, v8, v137
  v_mul_f32 v18, v8, v138
  v_mul_f32 v19, v8, v139
  v_exp_f32 v16, v16
  v_exp_f32 v17, v17
  v_exp_f32 v18, v18
  v_exp_f32 v19, v19
  v_mul_f32 v20, v136, v152
  v_mul_f32 v21, v137, v153
  v_mul_f32 v22, v138, v154
  v_mul_f32 v23, v139, v155
  v_add_f32 v16, 1.0, v16
  v_add_f32 v17, 1.0, v17
  v_add_f32 v18, 1.0, v18
  v_add_f32 v19, 1.0, v19
  v_rcp_f32 v16, v16
  v_rcp_f32 v17, v17
  v_rcp_f32 v18, v18
  v_rcp_f32 v19, v19
  v_mul_f32 v20, v12, v20
  v_mul_f32 v21, v12, v21
  v_mul_f32 v22, v12, v22
  v_mul_f32 v23, v12, v23
  v_mul_f32 v20, v20, v16
  v_mul_f32 v21, v21, v17
  v_mul_f32 v22, v22, v18
  v_mul_f32 v23, v23, v19
  v_cvt_pk_bf16_f32 v48, v20, v21
  v_cvt_pk_bf16_f32 v49, v22, v23
  v_mul_f32 v24, v9, v140
  v_mul_f32 v25, v9, v141
  v_mul_f32 v26, v9, v142
  v_mul_f32 v27, v9, v143
  v_exp_f32 v24, v24
  v_exp_f32 v25, v25
  v_exp_f32 v26, v26
  v_exp_f32 v27, v27
  v_mul_f32 v28, v140, v156
  v_mul_f32 v29, v141, v157
  v_mul_f32 v30, v142, v158
  v_mul_f32 v31, v143, v159
  v_add_f32 v24, 1.0, v24
  v_add_f32 v25, 1.0, v25
  v_add_f32 v26, 1.0, v26
  v_add_f32 v27, 1.0, v27
  v_rcp_f32 v24, v24
  v_rcp_f32 v25, v25
  v_rcp_f32 v26, v26
  v_rcp_f32 v27, v27
  v_mul_f32 v28, v13, v28
  v_mul_f32 v29, v13, v29
  v_mul_f32 v30, v13, v30
  v_mul_f32 v31, v13, v31
  v_mul_f32 v28, v28, v24
  v_mul_f32 v29, v29, v25
  v_mul_f32 v30, v30, v26
  v_mul_f32 v31, v31, v27
  v_cvt_pk_bf16_f32 v50, v28, v29
  v_cvt_pk_bf16_f32 v51, v30, v31
  s_nop 1
  v_permlane16_swap_b32 v48, v50
  v_permlane16_swap_b32 v49, v51
  buffer_store_dwordx4 v[48:51], v7, s[28:31], s44 offen sc1
  v_mul_f32 v16, v10, v144
  v_mul_f32 v17, v10, v145
  v_mul_f32 v18, v10, v146
  v_mul_f32 v19, v10, v147
  v_exp_f32 v16, v16
  v_exp_f32 v17, v17
  v_exp_f32 v18, v18
  v_exp_f32 v19, v19
  v_mul_f32 v20, v144, v160
  v_mul_f32 v21, v145, v161
  v_mul_f32 v22, v146, v162
  v_mul_f32 v23, v147, v163
  v_add_f32 v16, 1.0, v16
  v_add_f32 v17, 1.0, v17
  v_add_f32 v18, 1.0, v18
  v_add_f32 v19, 1.0, v19
  v_rcp_f32 v16, v16
  v_rcp_f32 v17, v17
  v_rcp_f32 v18, v18
  v_rcp_f32 v19, v19
  v_mul_f32 v20, v14, v20
  v_mul_f32 v21, v14, v21
  v_mul_f32 v22, v14, v22
  v_mul_f32 v23, v14, v23
  v_mul_f32 v20, v20, v16
  v_mul_f32 v21, v21, v17
  v_mul_f32 v22, v22, v18
  v_mul_f32 v23, v23, v19
  v_cvt_pk_bf16_f32 v52, v20, v21
  v_cvt_pk_bf16_f32 v53, v22, v23
  v_mul_f32 v24, v11, v148
  v_mul_f32 v25, v11, v149
  v_mul_f32 v26, v11, v150
  v_mul_f32 v27, v11, v151
  v_exp_f32 v24, v24
  v_exp_f32 v25, v25
  v_exp_f32 v26, v26
  v_exp_f32 v27, v27
  v_mul_f32 v28, v148, v164
  v_mul_f32 v29, v149, v165
  v_mul_f32 v30, v150, v166
  v_mul_f32 v31, v151, v167
  v_add_f32 v24, 1.0, v24
  v_add_f32 v25, 1.0, v25
  v_add_f32 v26, 1.0, v26
  v_add_f32 v27, 1.0, v27
  v_rcp_f32 v24, v24
  v_rcp_f32 v25, v25
  v_rcp_f32 v26, v26
  v_rcp_f32 v27, v27
  v_mul_f32 v28, v15, v28
  v_mul_f32 v29, v15, v29
  v_mul_f32 v30, v15, v30
  v_mul_f32 v31, v15, v31
  v_mul_f32 v28, v28, v24
  v_mul_f32 v29, v29, v25
  v_mul_f32 v30, v30, v26
  v_mul_f32 v31, v31, v27
  v_cvt_pk_bf16_f32 v54, v28, v29
  v_cvt_pk_bf16_f32 v55, v30, v31
  s_nop 1
  v_permlane16_swap_b32 v52, v54
  v_permlane16_swap_b32 v53, v55
  buffer_store_dwordx4 v[52:55], v7, s[28:31], s45 offen sc1
L_k5_end:
  s_endpgm
.globl ffn2_kernel
.p2align 8
.type ffn2_kernel,@function
ffn2_kernel:
  s_load_dwordx2 s[8:9], s[0:1], 64
  s_load_dwordx4 s[12:15], s[0:1], 88
  s_load_dwordx2 s[20:21], s[0:1], 104
  v_and_b32 v136, 63, v0
  v_lshrrev_b32 v2, 6, v0
  s_nop 0
  v_readfirstlane_b32 s3, v2
  s_cmp_ge_u32 s2, 256
  s_cbranch_scc1 L_k6_end
  s_and_b32 s22, s2, 7
  s_lshr_b32 s23, s2, 3
  s_lshr_b32 s24, s22, 1
  s_and_b32 s22, s22, 1
  s_lshl_b32 s22, s22, 3
  s_and_b32 s25, s23, 7
  s_add_u32 s22, s22, s25
  s_lshr_b32 s23, s23, 3
  s_and_b32 s25, s3, 3
  s_lshr_b32 s26, s3, 2
  v_and_b32 v137, 15, v136
  v_lshrrev_b32 v138, 4, v136
  s_waitcnt lgkmcnt(0)
  s_cmp_ge_u32 s3, 8
  s_cbranch_scc0 L_k6_main
  s_cmp_ge_u32 s3, 10
  s_cbranch_scc1 L_k6_wl
  s_add_u32 s40, s20, 11182080
  s_addc_u32 s41, s21, 0
  s_mov_b32 s42, 18874368
  s_mov_b32 s43, 0x20000
  s_sub_u32 s76, s3, 8
  s_lshl_b32 s60, s22, 2
  s_lshl_b32 s77, s76, 1
  s_add_u32 s60, s60, s77
  s_lshl_b32 s60, s60, 12
  s_mul_i32 s77, s24, 4718592
  s_add_u32 s60, s60, s77
  s_add_u32 s61, s60, 4096
  s_lshl_b32 s70, s76, 13
  v_lshlrev_b32 v0, 4, v136
  s_mov_b32 s71, 0
  s_add_u32 s79, s70, s71
  s_add_u32 m0, s79, 0
  s_nop 0
  buffer_load_dwordx4 v0, s[40:43], s60 offen offset:0 lds
  buffer_load_dwordx4 v0, s[40:43], s60 offen offset:1024 lds
  buffer_load_dwordx4 v0, s[40:43], s60 offen offset:2048 lds
  buffer_load_dwordx4 v0, s[40:43], s60 offen offset:3072 lds
  s_add_u32 s60, s60, 262144
  s_add_u32 s79, s70, s71
  s_add_u32 m0, s79, 4096
  s_nop 0
  buffer_load_dwordx4 v0, s[40:43], s61 offen offset:0 lds
  buffer_load_dwordx4 v0, s[40:43], s61 offen offset:1024 lds
  buffer_load_dwordx4 v0, s[40:43], s61 offen offset:2048 lds
  buffer_load_dwordx4 v0, s[40:43], s61 offen offset:3072 lds
  s_add_u32 s61, s61, 262144
  s_add_u32 s71, s71, 36864
  s_cmp_eq_u32 s71, 147456
  s_cselect_b32 s71, 0, s71
  s_add_u32 s79, s70, s71
  s_add_u32 m0, s79, 0
  s_nop 0
  buffer_load_dwordx4 v0, s[40:43], s60 offen offset:0 lds
  buffer_load_dwordx4 v0, s[40:43], s60 offen offset:1024 lds
  buffer_load_dwordx4 v0, s[40:43], s60 offen offset:2048 lds
  buffer_load_dwordx4 v0, s[40:43], s60 offen offset:3072 lds
  s_add_u32 s60, s60, 262144
  s_add_u32 s79, s70, s71
  s_add_u32 m0, s79, 4096
  s_nop 0
  buffer_load_dwordx4 v0, s[40:43], s61 offen offset:0 lds
  buffer_load_dwordx4 v0, s[40:43], s61 offen offset:1024 lds
  buffer_load_dwordx4 v0, s[40:43], s61 offen offset:2048 lds
  buffer_load_dwordx4 v0, s[40:43], s61 offen offset:3072 lds
  s_add_u32 s61, s61, 262144
  s_add_u32 s71, s71, 36864
  s_cmp_eq_u32 s71, 147456
  s_cselect_b32 s71, 0, s71
  s_add_u32 s79, s70, s71
  s_add_u32 m0, s79, 0
  s_nop 0
  buffer_load_dwordx4 v0, s[40:43], s60 offen offset:0 lds
  buffer_load_dwordx4 v0, s[40:43], s60 offen offset:1024 lds
  buffer_load_dwordx4 v0, s[40:43], s60 offen offset:2048 lds
  buffer_load_dwordx4 v0, s[40:43], s60 offen offset:3072 lds
  s_add_u32 s60, s60, 262144
  s_add_u32 s79, s70, s71
  s_add_u32 m0, s79, 4096
  s_nop 0
  buffer_load_dwordx4 v0, s[40:43], s61 offen offset:0 lds
  buffer_load_dwordx4 v0, s[40:43], s61 offen offset:1024 lds
  buffer_load_dwordx4 v0, s[40:43], s61 offen offset:2048 lds
  buffer_load_dwordx4 v0, s[40:43], s61 offen offset:3072 lds
  s_add_u32 s61, s61, 262144
  s_add_u32 s71, s71, 36864
  s_cmp_eq_u32 s71, 147456
  s_cselect_b32 s71, 0, s71
  s_waitcnt vmcnt(16)
  s_barrier
  s_mov_b32 s72, 15
L_ffn2_kernel_ld_1:
  s_waitcnt vmcnt(8)
  s_barrier
  s_add_u32 s79, s70, s71
  s_add_u32 m0, s79, 0
  s_nop 0
  buffer_load_dwordx4 v0, s[40:43], s60 offen offset:0 lds
  buffer_load_dwordx4 v0, s[40:43], s60 offen offset:1024 lds
  buffer_load_dwordx4 v0, s[40:43], s60 offen offset:2048 lds
  buffer_load_dwordx4 v0, s[40:43], s60 offen offset:3072 lds
  s_add_u32 s60, s60, 262144
  s_add_u32 s79, s70, s71
  s_add_u32 m0, s79, 4096
  s_nop 0
  buffer_load_dwordx4 v0, s[40:43], s61 offen offset:0 lds
  buffer_load_dwordx4 v0, s[40:43], s61 offen offset:1024 lds
  buffer_load_dwordx4 v0, s[40:43], s61 offen offset:2048 lds
  buffer_load_dwordx4 v0, s[40:43], s61 offen offset:3072 lds
  s_add_u32 s61, s61, 262144
  s_add_u32 s71, s71, 36864
  s_cmp_eq_u32 s71, 147456
  s_cselect_b32 s71, 0, s71
  s_sub_u32 s72, s72, 1
  s_cmp_lg_u32 s72, 0
  s_cbranch_scc1 L_ffn2_kernel_ld_1
  s_waitcnt vmcnt(0)
  s_barrier
  s_branch L_k6_tail
L_k6_wl:
  s_mov_b32 s40, s8
  s_mov_b32 s41, s9
  s_mov_b32 s42, 5308416
  s_mov_b32 s43, 0x20000
  s_mul_i32 s60, s24, 1327104
  s_mul_i32 s77, s23, 288
  s_add_u32 s60, s60, s77
  s_sub_u32 s76, s3, 10
  s_mul_i32 s76, s76, 640
  s_lshl_b32 s70, s76, 4
  s_add_u32 s70, s70, 16384
  v_add_u32 v139, s76, v136
  v_mul_u32_u24 v140, 863, v139
  v_lshrrev_b32 v140, 17, v140
  v_mul_u32_u24 v141, 152, v140
  v_sub_u32 v139, v139, v141
  v_min_u32 v139, 143, v139
  v_min_u32 v140, 7, v140
  v_mul_u32_u24 v141, 3641, v139
  v_lshrrev_b32 v141, 16, v141
  v_lshl_add_u32 v140, v140, 3, v141
  v_mul_u32_u24 v141, 18, v141
  v_sub_u32 v139, v139, v141
  v_mul_u32_u24 v140, 1152, v140
  v_lshl_add_u32 v0, v139, 4, v140
  s_add_u32 s76, s76, 64
  v_add_u32 v139, s76, v136
  v_mul_u32_u24 v140, 863, v139
  v_lshrrev_b32 v140, 17, v140
  v_mul_u32_u24 v141, 152, v140
  v_sub_u32 v139, v139, v141
  v_min_u32 v139, 143, v139
  v_min_u32 v140, 7, v140
  v_mul_u32_u24 v141, 3641, v139
  v_lshrrev_b32 v141, 16, v141
  v_lshl_add_u32 v140, v140, 3, v141
  v_mul_u32_u24 v141, 18, v141
  v_sub_u32 v139, v139, v141
  v_mul_u32_u24 v140, 1152, v140
  v_lshl_add_u32 v1, v139, 4, v140
  s_add_u32 s76, s76, 64
  v_add_u32 v139, s76, v136
  v_mul_u32_u24 v140, 863, v139
  v_lshrrev_b32 v140, 17, v140
  v_mul_u32_u24 v141, 152, v140
  v_sub_u32 v139, v139, v141
  v_min_u32 v139, 143, v139
  v_min_u32 v140, 7, v140
  v_mul_u32_u24 v141, 3641, v139
  v_lshrrev_b32 v141, 16, v141
  v_lshl_add_u32 v140, v140, 3, v141
  v_mul_u32_u24 v141, 18, v141
  v_sub_u32 v139, v139, v141
  v_mul_u32_u24 v140, 1152, v140
  v_lshl_add_u32 v2, v139, 4, v140
  s_add_u32 s76, s76, 64
  v_add_u32 v139, s76, v136
  v_mul_u32_u24 v140, 863, v139
  v_lshrrev_b32 v140, 17, v140
  v_mul_u32_u24 v141, 152, v140
  v_sub_u32 v139, v139, v141
  v_min_u32 v139, 143, v139
  v_min_u32 v140, 7, v140
  v_mul_u32_u24 v141, 3641, v139
  v_lshrrev_b32 v141, 16, v141
  v_lshl_add_u32 v140, v140, 3, v141
  v_mul_u32_u24 v141, 18, v141
  v_sub_u32 v139, v139, v141
  v_mul_u32_u24 v140, 1152, v140
  v_lshl_add_u32 v3, v139, 4, v140
  s_add_u32 s76, s76, 64
  v_add_u32 v139, s76, v136
  v_mul_u32_u24 v140, 863, v139
  v_lshrrev_b32 v140, 17, v140
  v_mul_u32_u24 v141, 152, v140
  v_sub_u32 v139, v139, v141
  v_min_u32 v139, 143, v139
  v_min_u32 v140, 7, v140
  v_mul_u32_u24 v141, 3641, v139
  v_lshrrev_b32 v141, 16, v141
  v_lshl_add_u32 v140, v140, 3, v141
  v_mul_u32_u24 v141, 18, v141
  v_sub_u32 v139, v139, v141
  v_mul_u32_u24 v140, 1152, v140
  v_lshl_add_u32 v4, v139, 4, v140
  s_add_u32 s76, s76, 64
  v_add_u32 v139, s76, v136
  v_mul_u32_u24 v140, 863, v139
  v_lshrrev_b32 v140, 17, v140
  v_mul_u32_u24 v141, 152, v140
  v_sub_u32 v139, v139, v141
  v_min_u32 v139, 143, v139
  v_min_u32 v140, 7, v140
  v_mul_u32_u24 v141, 3641, v139
  v_lshrrev_b32 v141, 16, v141
  v_lshl_add_u32 v140, v140, 3, v141
  v_mul_u32_u24 v141, 18, v141
  v_sub_u32 v139, v139, v141
  v_mul_u32_u24 v140, 1152, v140
  v_lshl_add_u32 v5, v139, 4, v140
  s_add_u32 s76, s76, 64
  v_add_u32 v139, s76, v136
  v_mul_u32_u24 v140, 863, v139
  v_lshrrev_b32 v140, 17, v140
  v_mul_u32_u24 v141, 152, v140
  v_sub_u32 v139, v139, v141
  v_min_u32 v139, 143, v139
  v_min_u32 v140, 7, v140
  v_mul_u32_u24 v141, 3641, v139
  v_lshrrev_b32 v141, 16, v141
  v_lshl_add_u32 v140, v140, 3, v141
  v_mul_u32_u24 v141, 18, v141
  v_sub_u32 v139, v139, v141
  v_mul_u32_u24 v140, 1152, v140
  v_lshl_add_u32 v6, v139, 4, v140
  s_add_u32 s76, s76, 64
  v_add_u32 v139, s76, v136
  v_mul_u32_u24 v140, 863, v139
  v_lshrrev_b32 v140, 17, v140
  v_mul_u32_u24 v141, 152, v140
  v_sub_u32 v139, v139, v141
  v_min_u32 v139, 143, v139
  v_min_u32 v140, 7, v140
  v_mul_u32_u24 v141, 3641, v139
  v_lshrrev_b32 v141, 16, v141
  v_lshl_add_u32 v140, v140, 3, v141
  v_mul_u32_u24 v141, 18, v141
  v_sub_u32 v139, v139, v141
  v_mul_u32_u24 v140, 1152, v140
  v_lshl_add_u32 v7, v139, 4, v140
  s_add_u32 s76, s76, 64
  v_add_u32 v139, s76, v136
  v_mul_u32_u24 v140, 863, v139
  v_lshrrev_b32 v140, 17, v140
  v_mul_u32_u24 v141, 152, v140
  v_sub_u32 v139, v139, v141
  v_min_u32 v139, 143, v139
  v_min_u32 v140, 7, v140
  v_mul_u32_u24 v141, 3641, v139
  v_lshrrev_b32 v141, 16, v141
  v_lshl_add_u32 v140, v140, 3, v141
  v_mul_u32_u24 v141, 18, v141
  v_sub_u32 v139, v139, v141
  v_mul_u32_u24 v140, 1152, v140
  v_lshl_add_u32 v8, v139, 4, v140
  s_add_u32 s76, s76, 64
  v_add_u32 v139, s76, v136
  v_mul_u32_u24 v140, 863, v139
  v_lshrrev_b32 v140, 17, v140
  v_mul_u32_u24 v141, 152, v140
  v_sub_u32 v139, v139, v141
  v_min_u32 v139, 143, v139
  v_min_u32 v140, 7, v140
  v_mul_u32_u24 v141, 3641, v139
  v_lshrrev_b32 v141, 16, v141
  v_lshl_add_u32 v140, v140, 3, v141
  v_mul_u32_u24 v141, 18, v141
  v_sub_u32 v139, v139, v141
  v_mul_u32_u24 v140, 1152, v140
  v_lshl_add_u32 v9, v139, 4, v140
  s_add_u32 s76, s76, 64
  s_mov_b32 s71, 0
  s_add_u32 s79, s70, s71
  s_add_u32 m0, s79, 0
  s_nop 0
  buffer_load_dwordx4 v0, s[40:43], s60 offen lds
  s_add_u32 m0, s79, 1024
  s_nop 0
  buffer_load_dwordx4 v1, s[40:43], s60 offen lds
  s_add_u32 m0, s79, 2048
  s_nop 0
  buffer_load_dwordx4 v2, s[40:43], s60 offen lds
  s_add_u32 m0, s79, 3072
  s_nop 0
  buffer_load_dwordx4 v3, s[40:43], s60 offen lds
  s_add_u32 m0, s79, 4096
  s_nop 0
  buffer_load_dwordx4 v4, s[40:43], s60 offen lds
  s_add_u32 m0, s79, 5120
  s_nop 0
  buffer_load_dwordx4 v5, s[40:43], s60 offen lds
  s_add_u32 m0, s79, 6144
  s_nop 0
  buffer_load_dwordx4 v6, s[40:43], s60 offen lds
  s_add_u32 m0, s79, 7168
  s_nop 0
  buffer_load_dwordx4 v7, s[40:43], s60 offen lds
  s_add_u32 m0, s79, 8192
  s_nop 0
  buffer_load_dwordx4 v8, s[40:43], s60 offen lds
  s_add_u32 m0, s79, 9216
  s_nop 0
  buffer_load_dwordx4 v9, s[40:43], s60 offen lds
  s_add_u32 s60, s60, 73728
  s_add_u32 s71, s71, 36864
  s_cmp_eq_u32 s71, 147456
  s_cselect_b32 s71, 0, s71
  s_add_u32 s79, s70, s71
  s_add_u32 m0, s79, 0
  s_nop 0
  buffer_load_dwordx4 v0, s[40:43], s60 offen lds
  s_add_u32 m0, s79, 1024
  s_nop 0
  buffer_load_dwordx4 v1, s[40:43], s60 offen lds
  s_add_u32 m0, s79, 2048
  s_nop 0
  buffer_load_dwordx4 v2, s[40:43], s60 offen lds
  s_add_u32 m0, s79, 3072
  s_nop 0
  buffer_load_dwordx4 v3, s[40:43], s60 offen lds
  s_add_u32 m0, s79, 4096
  s_nop 0
  buffer_load_dwordx4 v4, s[40:43], s60 offen lds
  s_add_u32 m0, s79, 5120
  s_nop 0
  buffer_load_dwordx4 v5, s[40:43], s60 offen lds
  s_add_u32 m0, s79, 6144
  s_nop 0
  buffer_load_dwordx4 v6, s[40:43], s60 offen lds
  s_add_u32 m0, s79, 7168
  s_nop 0
  buffer_load_dwordx4 v7, s[40:43], s60 offen lds
  s_add_u32 m0, s79, 8192
  s_nop 0
  buffer_load_dwordx4 v8, s[40:43], s60 offen lds
  s_add_u32 m0, s79, 9216
  s_nop 0
  buffer_load_dwordx4 v9, s[40:43], s60 offen lds
  s_add_u32 s60, s60, 73728
  s_add_u32 s71, s71, 36864
  s_cmp_eq_u32 s71, 147456
  s_cselect_b32 s71, 0, s71
  s_add_u32 s79, s70, s71
  s_add_u32 m0, s79, 0
  s_nop 0
  buffer_load_dwordx4 v0, s[40:43], s60 offen lds
  s_add_u32 m0, s79, 1024
  s_nop 0
  buffer_load_dwordx4 v1, s[40:43], s60 offen lds
  s_add_u32 m0, s79, 2048
  s_nop 0
  buffer_load_dwordx4 v2, s[40:43], s60 offen lds
  s_add_u32 m0, s79, 3072
  s_nop 0
  buffer_load_dwordx4 v3, s[40:43], s60 offen lds
  s_add_u32 m0, s79, 4096
  s_nop 0
  buffer_load_dwordx4 v4, s[40:43], s60 offen lds
  s_add_u32 m0, s79, 5120
  s_nop 0
  buffer_load_dwordx4 v5, s[40:43], s60 offen lds
  s_add_u32 m0, s79, 6144
  s_nop 0
  buffer_load_dwordx4 v6, s[40:43], s60 offen lds
  s_add_u32 m0, s79, 7168
  s_nop 0
  buffer_load_dwordx4 v7, s[40:43], s60 offen lds
  s_add_u32 m0, s79, 8192
  s_nop 0
  buffer_load_dwordx4 v8, s[40:43], s60 offen lds
  s_add_u32 m0, s79, 9216
  s_nop 0
  buffer_load_dwordx4 v9, s[40:43], s60 offen lds
  s_add_u32 s60, s60, 73728
  s_add_u32 s71, s71, 36864
  s_cmp_eq_u32 s71, 147456
  s_cselect_b32 s71, 0, s71
  s_waitcnt vmcnt(20)
  s_barrier
  s_mov_b32 s72, 15
L_ffn2_kernel_ld_2:
  s_waitcnt vmcnt(10)
  s_barrier
  s_add_u32 s79, s70, s71
  s_add_u32 m0, s79, 0
  s_nop 0
  buffer_load_dwordx4 v0, s[40:43], s60 offen lds
  s_add_u32 m0, s79, 1024
  s_nop 0
  buffer_load_dwordx4 v1, s[40:43], s60 offen lds
  s_add_u32 m0, s79, 2048
  s_nop 0
  buffer_load_dwordx4 v2, s[40:43], s60 offen lds
  s_add_u32 m0, s79, 3072
  s_nop 0
  buffer_load_dwordx4 v3, s[40:43], s60 offen lds
  s_add_u32 m0, s79, 4096
  s_nop 0
  buffer_load_dwordx4 v4, s[40:43], s60 offen lds
  s_add_u32 m0, s79, 5120
  s_nop 0
  buffer_load_dwordx4 v5, s[40:43], s60 offen lds
  s_add_u32 m0, s79, 6144
  s_nop 0
  buffer_load_dwordx4 v6, s[40:43], s60 offen lds
  s_add_u32 m0, s79, 7168
  s_nop 0
  buffer_load_dwordx4 v7, s[40:43], s60 offen lds
  s_add_u32 m0, s79, 8192
  s_nop 0
  buffer_load_dwordx4 v8, s[40:43], s60 offen lds
  s_add_u32 m0, s79, 9216
  s_nop 0
  buffer_load_dwordx4 v9, s[40:43], s60 offen lds
  s_add_u32 s60, s60, 73728
  s_add_u32 s71, s71, 36864
  s_cmp_eq_u32 s71, 147456
  s_cselect_b32 s71, 0, s71
  s_sub_u32 s72, s72, 1
  s_cmp_lg_u32 s72, 0
  s_cbranch_scc1 L_ffn2_kernel_ld_2
  s_waitcnt vmcnt(0)
  s_barrier
  s_branch L_k6_tail
L_k6_main:
  v_lshrrev_b32 v139, 1, v138
  v_lshlrev_b32 v139, 10, v139
  v_and_b32 v140, 1, v138
  v_lshl_add_u32 v139, v140, 9, v139
  v_lshl_add_u32 v139, v137, 4, v139
  s_lshl_b32 s76, s25, 12
  v_add_u32 v5, s76, v139
  v_add_u32 v6, 73728, v5
  v_bfe_u32 v139, v136, 2, 2
  v_lshl_add_u32 v139, v138, 3, v139
  v_mul_u32_u24 v139, 288, v139
  v_lshl_add_u32 v139, v138, 7, v139
  v_and_b32 v140, 3, v136
  v_lshl_add_u32 v139, v140, 3, v139
  s_mul_i32 s76, s26, 160
  v_add_u32 v7, s76, v139
  v_add_u32 v8, 73728, v7
  v_lshlrev_b32 v140, 4, v136
  s_lshl_b32 s40, s24, 4
  s_add_u32 s40, s40, s22
  s_lshl_b32 s40, s40, 2
  s_add_u32 s40, s40, s23
  s_lshl_b32 s40, s40, 2
  s_add_u32 s40, s40, s25
  s_mul_i32 s40, s40, 9216
  s_mul_i32 s76, s26, 5120
  s_add_u32 s40, s40, s76
  s_add_u32 s28, s20, 30056448
  s_addc_u32 s29, s21, 0
  s_mov_b32 s30, 18874368
  s_mov_b32 s31, 0x20000
  v_mov_b32 v84, 0
  v_mov_b32 v85, 0
  v_mov_b32 v86, 0
  v_mov_b32 v87, 0
  v_mov_b32 v88, 0
  v_mov_b32 v89, 0
  v_mov_b32 v90, 0
  v_mov_b32 v91, 0
  v_mov_b32 v92, 0
  v_mov_b32 v93, 0
  v_mov_b32 v94, 0
  v_mov_b32 v95, 0
  v_mov_b32 v96, 0
  v_mov_b32 v97, 0
  v_mov_b32 v98, 0
  v_mov_b32 v99, 0
  v_mov_b32 v100, 0
  v_mov_b32 v101, 0
  v_mov_b32 v102, 0
  v_mov_b32 v103, 0
  v_mov_b32 v104, 0
  v_mov_b32 v105, 0
  v_mov_b32 v106, 0
  v_mov_b32 v107, 0
  v_mov_b32 v108, 0
  v_mov_b32 v109, 0
  v_mov_b32 v110, 0
  v_mov_b32 v111, 0
  v_mov_b32 v112, 0
  v_mov_b32 v113, 0
  v_mov_b32 v114, 0
  v_mov_b32 v115, 0
  v_mov_b32 v116, 0
  v_mov_b32 v117, 0
  v_mov_b32 v118, 0
  v_mov_b32 v119, 0
  v_mov_b32 v120, 0
  v_mov_b32 v121, 0
  v_mov_b32 v122, 0
  v_mov_b32 v123, 0
  s_cmp_eq_u32 s26, 1
  s_cbranch_scc1 L_k6_c1
  s_barrier
  ds_read_b128 v[52:55], v5 offset:0
  ds_read_b128 v[56:59], v5 offset:256
  ds_read_b128 v[60:63], v5 offset:2048
  ds_read_b128 v[64:67], v5 offset:2304
  ds_read_b64_tr_b16 v[12:13], v7 offset:16384
  ds_read_b64_tr_b16 v[14:15], v7 offset:17536
  ds_read_b64_tr_b16 v[16:17], v7 offset:16416
  ds_read_b64_tr_b16 v[18:19], v7 offset:17568
  ds_read_b64_tr_b16 v[20:21], v7 offset:16448
  ds_read_b64_tr_b16 v[22:23], v7 offset:17600
  ds_read_b64_tr_b16 v[24:25], v7 offset:16480
  ds_read_b64_tr_b16 v[26:27], v7 offset:17632
  ds_read_b64_tr_b16 v[28:29], v7 offset:16512
  ds_read_b64_tr_b16 v[30:31], v7 offset:17664
  ds_read_b64_tr_b16 v[32:33], v7 offset:26112
  ds_read_b64_tr_b16 v[34:35], v7 offset:27264
  ds_read_b64_tr_b16 v[36:37], v7 offset:26144
  ds_read_b64_tr_b16 v[38:39], v7 offset:27296
  ds_read_b64_tr_b16 v[40:41], v7 offset:26176
  ds_read_b64_tr_b16 v[42:43], v7 offset:27328
  ds_read_b64_tr_b16 v[44:45], v7 offset:26208
  ds_read_b64_tr_b16 v[46:47], v7 offset:27360
  ds_read_b64_tr_b16 v[48:49], v7 offset:26240
  ds_read_b64_tr_b16 v[50:51], v7 offset:27392
  s_mov_b32 s41, 7
.p2align 6
L_k6_loop0:
  s_waitcnt lgkmcnt(15)
  v_mfma_f32_16x16x32_bf16 v[84:87], v[12:15], v[52:55], v[84:87]
  v_mfma_f32_16x16x32_bf16 v[88:91], v[12:15], v[56:59], v[88:91]
  v_mfma_f32_16x16x32_bf16 v[92:95], v[16:19], v[52:55], v[92:95]
  v_mfma_f32_16x16x32_bf16 v[96:99], v[16:19], v[56:59], v[96:99]
  s_barrier
  ds_read_b128 v[68:71], v5 offset:36864
  ds_read_b128 v[72:75], v5 offset:37120
  ds_read_b128 v[76:79], v5 offset:38912
  ds_read_b128 v[80:83], v5 offset:39168
  ds_read_b64_tr_b16 v[12:13], v7 offset:53248
  ds_read_b64_tr_b16 v[14:15], v7 offset:54400
  ds_read_b64_tr_b16 v[16:17], v7 offset:53280
  ds_read_b64_tr_b16 v[18:19], v7 offset:54432
  s_waitcnt lgkmcnt(15)
  v_mfma_f32_16x16x32_bf16 v[100:103], v[20:23], v[52:55], v[100:103]
  v_mfma_f32_16x16x32_bf16 v[104:107], v[20:23], v[56:59], v[104:107]
  ds_read_b64_tr_b16 v[20:21], v7 offset:53312
  ds_read_b64_tr_b16 v[22:23], v7 offset:54464
  v_mfma_f32_16x16x32_bf16 v[108:111], v[24:27], v[52:55], v[108:111]
  v_mfma_f32_16x16x32_bf16 v[112:115], v[24:27], v[56:59], v[112:115]
  ds_read_b64_tr_b16 v[24:25], v7 offset:53344
  ds_read_b64_tr_b16 v[26:27], v7 offset:54496
  v_mfma_f32_16x16x32_bf16 v[116:119], v[28:31], v[52:55], v[116:119]
  v_mfma_f32_16x16x32_bf16 v[120:123], v[28:31], v[56:59], v[120:123]
  ds_read_b64_tr_b16 v[28:29], v7 offset:53376
  ds_read_b64_tr_b16 v[30:31], v7 offset:54528
  v_mfma_f32_16x16x32_bf16 v[84:87], v[32:35], v[60:63], v[84:87]
  v_mfma_f32_16x16x32_bf16 v[88:91], v[32:35], v[64:67], v[88:91]
  ds_read_b64_tr_b16 v[32:33], v7 offset:62976
  ds_read_b64_tr_b16 v[34:35], v7 offset:64128
  s_waitcnt lgkmcnt(15)
  v_mfma_f32_16x16x32_bf16 v[92:95], v[36:39], v[60:63], v[92:95]
  v_mfma_f32_16x16x32_bf16 v[96:99], v[36:39], v[64:67], v[96:99]
  ds_read_b64_tr_b16 v[36:37], v7 offset:63008
  ds_read_b64_tr_b16 v[38:39], v7 offset:64160
  v_mfma_f32_16x16x32_bf16 v[100:103], v[40:43], v[60:63], v[100:103]
  v_mfma_f32_16x16x32_bf16 v[104:107], v[40:43], v[64:67], v[104:107]
  ds_read_b64_tr_b16 v[40:41], v7 offset:63040
  ds_read_b64_tr_b16 v[42:43], v7 offset:64192
  v_mfma_f32_16x16x32_bf16 v[108:111], v[44:47], v[60:63], v[108:111]
  v_mfma_f32_16x16x32_bf16 v[112:115], v[44:47], v[64:67], v[112:115]
  ds_read_b64_tr_b16 v[44:45], v7 offset:63072
  ds_read_b64_tr_b16 v[46:47], v7 offset:64224
  v_mfma_f32_16x16x32_bf16 v[116:119], v[48:51], v[60:63], v[116:119]
  v_mfma_f32_16x16x32_bf16 v[120:123], v[48:51], v[64:67], v[120:123]
  ds_read_b64_tr_b16 v[48:49], v7 offset:63104
  ds_read_b64_tr_b16 v[50:51], v7 offset:64256
  s_waitcnt lgkmcnt(15)
  v_mfma_f32_16x16x32_bf16 v[84:87], v[12:15], v[68:71], v[84:87]
  v_mfma_f32_16x16x32_bf16 v[88:91], v[12:15], v[72:75], v[88:91]
  v_mfma_f32_16x16x32_bf16 v[92:95], v[16:19], v[68:71], v[92:95]
  v_mfma_f32_16x16x32_bf16 v[96:99], v[16:19], v[72:75], v[96:99]
  s_barrier
  ds_read_b128 v[52:55], v6 offset:0
  ds_read_b128 v[56:59], v6 offset:256
  ds_read_b128 v[60:63], v6 offset:2048
  ds_read_b128 v[64:67], v6 offset:2304
  ds_read_b64_tr_b16 v[12:13], v8 offset:16384
  ds_read_b64_tr_b16 v[14:15], v8 offset:17536
  ds_read_b64_tr_b16 v[16:17], v8 offset:16416
  ds_read_b64_tr_b16 v[18:19], v8 offset:17568
  s_waitcnt lgkmcnt(15)
  v_mfma_f32_16x16x32_bf16 v[100:103], v[20:23], v[68:71], v[100:103]
  v_mfma_f32_16x16x32_bf16 v[104:107], v[20:23], v[72:75], v[104:107]
  ds_read_b64_tr_b16 v[20:21], v8 offset:16448
  ds_read_b64_tr_b16 v[22:23], v8 offset:17600
  v_mfma_f32_16x16x32_bf16 v[108:111], v[24:27], v[68:71], v[108:111]
  v_mfma_f32_16x16x32_bf16 v[112:115], v[24:27], v[72:75], v[112:115]
  ds_read_b64_tr_b16 v[24:25], v8 offset:16480
  ds_read_b64_tr_b16 v[26:27], v8 offset:17632
  v_mfma_f32_16x16x32_bf16 v[116:119], v[28:31], v[68:71], v[116:119]
  v_mfma_f32_16x16x32_bf16 v[120:123], v[28:31], v[72:75], v[120:123]
  ds_read_b64_tr_b16 v[28:29], v8 offset:16512
  ds_read_b64_tr_b16 v[30:31], v8 offset:17664
  v_mfma_f32_16x16x32_bf16 v[84:87], v[32:35], v[76:79], v[84:87]
  v_mfma_f32_16x16x32_bf16 v[88:91], v[32:35], v[80:83], v[88:91]
  ds_read_b64_tr_b16 v[32:33], v8 offset:26112
  ds_read_b64_tr_b16 v[34:35], v8 offset:27264
  s_waitcnt lgkmcnt(15)
  v_mfma_f32_16x16x32_bf16 v[92:95], v[36:39], v[76:79], v[92:95]
  v_mfma_f32_16x16x32_bf16 v[96:99], v[36:39], v[80:83], v[96:99]
  ds_read_b64_tr_b16 v[36:37], v8 offset:26144
  ds_read_b64_tr_b16 v[38:39], v8 offset:27296
  v_mfma_f32_16x16x32_bf16 v[100:103], v[40:43], v[76:79], v[100:103]
  v_mfma_f32_16x16x32_bf16 v[104:107], v[40:43], v[80:83], v[104:107]
  ds_read_b64_tr_b16 v[40:41], v8 offset:26176
  ds_read_b64_tr_b16 v[42:43], v8 offset:27328
  v_mfma_f32_16x16x32_bf16 v[108:111], v[44:47], v[76:79], v[108:111]
  v_mfma_f32_16x16x32_bf16 v[112:115], v[44:47], v[80:83], v[112:115]
  ds_read_b64_tr_b16 v[44:45], v8 offset:26208
  ds_read_b64_tr_b16 v[46:47], v8 offset:27360
  v_mfma_f32_16x16x32_bf16 v[116:119], v[48:51], v[76:79], v[116:119]
  v_mfma_f32_16x16x32_bf16 v[120:123], v[48:51], v[80:83], v[120:123]
  ds_read_b64_tr_b16 v[48:49], v8 offset:26240
  ds_read_b64_tr_b16 v[50:51], v8 offset:27392
  v_swap_b32 v5, v6
  v_swap_b32 v7, v8
  s_sub_u32 s41, s41, 1
  s_cmp_lg_u32 s41, 0
  s_cbranch_scc1 L_k6_loop0
  s_waitcnt lgkmcnt(15)
  v_mfma_f32_16x16x32_bf16 v[84:87], v[12:15], v[52:55], v[84:87]
  v_mfma_f32_16x16x32_bf16 v[88:91], v[12:15], v[56:59], v[88:91]
  v_mfma_f32_16x16x32_bf16 v[92:95], v[16:19], v[52:55], v[92:95]
  v_mfma_f32_16x16x32_bf16 v[96:99], v[16:19], v[56:59], v[96:99]
  s_barrier
  ds_read_b128 v[68:71], v5 offset:36864
  ds_read_b128 v[72:75], v5 offset:37120
  ds_read_b128 v[76:79], v5 offset:38912
  ds_read_b128 v[80:83], v5 offset:39168
  ds_read_b64_tr_b16 v[12:13], v7 offset:53248
  ds_read_b64_tr_b16 v[14:15], v7 offset:54400
  ds_read_b64_tr_b16 v[16:17], v7 offset:53280
  ds_read_b64_tr_b16 v[18:19], v7 offset:54432
  s_waitcnt lgkmcnt(15)
  v_mfma_f32_16x16x32_bf16 v[100:103], v[20:23], v[52:55], v[100:103]
  v_mfma_f32_16x16x32_bf16 v[104:107], v[20:23], v[56:59], v[104:107]
  ds_read_b64_tr_b16 v[20:21], v7 offset:53312
  ds_read_b64_tr_b16 v[22:23], v7 offset:54464
  v_mfma_f32_16x16x32_bf16 v[108:111], v[24:27], v[52:55], v[108:111]
  v_mfma_f32_16x16x32_bf16 v[112:115], v[24:27], v[56:59], v[112:115]
  ds_read_b64_tr_b16 v[24:25], v7 offset:53344
  ds_read_b64_tr_b16 v[26:27], v7 offset:54496
  v_mfma_f32_16x16x32_bf16 v[116:119], v[28:31], v[52:55], v[116:119]
  v_mfma_f32_16x16x32_bf16 v[120:123], v[28:31], v[56:59], v[120:123]
  ds_read_b64_tr_b16 v[28:29], v7 offset:53376
  ds_read_b64_tr_b16 v[30:31], v7 offset:54528
  v_mfma_f32_16x16x32_bf16 v[84:87], v[32:35], v[60:63], v[84:87]
  v_mfma_f32_16x16x32_bf16 v[88:91], v[32:35], v[64:67], v[88:91]
  ds_read_b64_tr_b16 v[32:33], v7 offset:62976
  ds_read_b64_tr_b16 v[34:35], v7 offset:64128
  s_waitcnt lgkmcnt(15)
  v_mfma_f32_16x16x32_bf16 v[92:95], v[36:39], v[60:63], v[92:95]
  v_mfma_f32_16x16x32_bf16 v[96:99], v[36:39], v[64:67], v[96:99]
  ds_read_b64_tr_b16 v[36:37], v7 offset:63008
  ds_read_b64_tr_b16 v[38:39], v7 offset:64160
  v_mfma_f32_16x16x32_bf16 v[100:103], v[40:43], v[60:63], v[100:103]
  v_mfma_f32_16x16x32_bf16 v[104:107], v[40:43], v[64:67], v[104:107]
  ds_read_b64_tr_b16 v[40:41], v7 offset:63040
  ds_read_b64_tr_b16 v[42:43], v7 offset:64192
  v_mfma_f32_16x16x32_bf16 v[108:111], v[44:47], v[60:63], v[108:111]
  v_mfma_f32_16x16x32_bf16 v[112:115], v[44:47], v[64:67], v[112:115]
  ds_read_b64_tr_b16 v[44:45], v7 offset:63072
  ds_read_b64_tr_b16 v[46:47], v7 offset:64224
  v_mfma_f32_16x16x32_bf16 v[116:119], v[48:51], v[60:63], v[116:119]
  v_mfma_f32_16x16x32_bf16 v[120:123], v[48:51], v[64:67], v[120:123]
  ds_read_b64_tr_b16 v[48:49], v7 offset:63104
  ds_read_b64_tr_b16 v[50:51], v7 offset:64256
  s_waitcnt lgkmcnt(15)
  v_mfma_f32_16x16x32_bf16 v[84:87], v[12:15], v[68:71], v[84:87]
  v_mfma_f32_16x16x32_bf16 v[88:91], v[12:15], v[72:75], v[88:91]
  v_mfma_f32_16x16x32_bf16 v[92:95], v[16:19], v[68:71], v[92:95]
  v_mfma_f32_16x16x32_bf16 v[96:99], v[16:19], v[72:75], v[96:99]
  s_barrier
  ds_read_b128 v[52:55], v6 offset:0
  ds_read_b128 v[56:59], v6 offset:256
  ds_read_b128 v[60:63], v6 offset:2048
  ds_read_b128 v[64:67], v6 offset:2304
  ds_read_b64_tr_b16 v[12:13], v8 offset:16384
  ds_read_b64_tr_b16 v[14:15], v8 offset:17536
  ds_read_b64_tr_b16 v[16:17], v8 offset:16416
  ds_read_b64_tr_b16 v[18:19], v8 offset:17568
  s_waitcnt lgkmcnt(15)
  v_mfma_f32_16x16x32_bf16 v[100:103], v[20:23], v[68:71], v[100:103]
  v_mfma_f32_16x16x32_bf16 v[104:107], v[20:23], v[72:75], v[104:107]
  ds_read_b64_tr_b16 v[20:21], v8 offset:16448
  ds_read_b64_tr_b16 v[22:23], v8 offset:17600
  v_mfma_f32_16x16x32_bf16 v[108:111], v[24:27], v[68:71], v[108:111]
  v_mfma_f32_16x16x32_bf16 v[112:115], v[24:27], v[72:75], v[112:115]
  ds_read_b64_tr_b16 v[24:25], v8 offset:16480
  ds_read_b64_tr_b16 v[26:27], v8 offset:17632
  v_mfma_f32_16x16x32_bf16 v[116:119], v[28:31], v[68:71], v[116:119]
  v_mfma_f32_16x16x32_bf16 v[120:123], v[28:31], v[72:75], v[120:123]
  ds_read_b64_tr_b16 v[28:29], v8 offset:16512
  ds_read_b64_tr_b16 v[30:31], v8 offset:17664
  v_mfma_f32_16x16x32_bf16 v[84:87], v[32:35], v[76:79], v[84:87]
  v_mfma_f32_16x16x32_bf16 v[88:91], v[32:35], v[80:83], v[88:91]
  ds_read_b64_tr_b16 v[32:33], v8 offset:26112
  ds_read_b64_tr_b16 v[34:35], v8 offset:27264
  s_waitcnt lgkmcnt(15)
  v_mfma_f32_16x16x32_bf16 v[92:95], v[36:39], v[76:79], v[92:95]
  v_mfma_f32_16x16x32_bf16 v[96:99], v[36:39], v[80:83], v[96:99]
  ds_read_b64_tr_b16 v[36:37], v8 offset:26144
  ds_read_b64_tr_b16 v[38:39], v8 offset:27296
  v_mfma_f32_16x16x32_bf16 v[100:103], v[40:43], v[76:79], v[100:103]
  v_mfma_f32_16x16x32_bf16 v[104:107], v[40:43], v[80:83], v[104:107]
  ds_read_b64_tr_b16 v[40:41], v8 offset:26176
  ds_read_b64_tr_b16 v[42:43], v8 offset:27328
  v_mfma_f32_16x16x32_bf16 v[108:111], v[44:47], v[76:79], v[108:111]
  v_mfma_f32_16x16x32_bf16 v[112:115], v[44:47], v[80:83], v[112:115]
  ds_read_b64_tr_b16 v[44:45], v8 offset:26208
  ds_read_b64_tr_b16 v[46:47], v8 offset:27360
  v_mfma_f32_16x16x32_bf16 v[116:119], v[48:51], v[76:79], v[116:119]
  v_mfma_f32_16x16x32_bf16 v[120:123], v[48:51], v[80:83], v[120:123]
  ds_read_b64_tr_b16 v[48:49], v8 offset:26240
  ds_read_b64_tr_b16 v[50:51], v8 offset:27392
  v_swap_b32 v5, v6
  v_swap_b32 v7, v8
  s_waitcnt lgkmcnt(15)
  v_mfma_f32_16x16x32_bf16 v[84:87], v[12:15], v[52:55], v[84:87]
  v_mfma_f32_16x16x32_bf16 v[88:91], v[12:15], v[56:59], v[88:91]
  v_mfma_f32_16x16x32_bf16 v[92:95], v[16:19], v[52:55], v[92:95]
  v_mfma_f32_16x16x32_bf16 v[96:99], v[16:19], v[56:59], v[96:99]
  ds_read_b128 v[68:71], v5 offset:36864
  ds_read_b128 v[72:75], v5 offset:37120
  ds_read_b128 v[76:79], v5 offset:38912
  ds_read_b128 v[80:83], v5 offset:39168
  ds_read_b64_tr_b16 v[12:13], v7 offset:53248
  ds_read_b64_tr_b16 v[14:15], v7 offset:54400
  ds_read_b64_tr_b16 v[16:17], v7 offset:53280
  ds_read_b64_tr_b16 v[18:19], v7 offset:54432
  s_waitcnt lgkmcnt(15)
  v_mfma_f32_16x16x32_bf16 v[100:103], v[20:23], v[52:55], v[100:103]
  v_mfma_f32_16x16x32_bf16 v[104:107], v[20:23], v[56:59], v[104:107]
  ds_read_b64_tr_b16 v[20:21], v7 offset:53312
  ds_read_b64_tr_b16 v[22:23], v7 offset:54464
  v_mfma_f32_16x16x32_bf16 v[108:111], v[24:27], v[52:55], v[108:111]
  v_mfma_f32_16x16x32_bf16 v[112:115], v[24:27], v[56:59], v[112:115]
  ds_read_b64_tr_b16 v[24:25], v7 offset:53344
  ds_read_b64_tr_b16 v[26:27], v7 offset:54496
  v_mfma_f32_16x16x32_bf16 v[116:119], v[28:31], v[52:55], v[116:119]
  v_mfma_f32_16x16x32_bf16 v[120:123], v[28:31], v[56:59], v[120:123]
  ds_read_b64_tr_b16 v[28:29], v7 offset:53376
  ds_read_b64_tr_b16 v[30:31], v7 offset:54528
  v_mfma_f32_16x16x32_bf16 v[84:87], v[32:35], v[60:63], v[84:87]
  v_mfma_f32_16x16x32_bf16 v[88:91], v[32:35], v[64:67], v[88:91]
  ds_read_b64_tr_b16 v[32:33], v7 offset:62976
  ds_read_b64_tr_b16 v[34:35], v7 offset:64128
  s_waitcnt lgkmcnt(15)
  v_mfma_f32_16x16x32_bf16 v[92:95], v[36:39], v[60:63], v[92:95]
  v_mfma_f32_16x16x32_bf16 v[96:99], v[36:39], v[64:67], v[96:99]
  ds_read_b64_tr_b16 v[36:37], v7 offset:63008
  ds_read_b64_tr_b16 v[38:39], v7 offset:64160
  v_mfma_f32_16x16x32_bf16 v[100:103], v[40:43], v[60:63], v[100:103]
  v_mfma_f32_16x16x32_bf16 v[104:107], v[40:43], v[64:67], v[104:107]
  ds_read_b64_tr_b16 v[40:41], v7 offset:63040
  ds_read_b64_tr_b16 v[42:43], v7 offset:64192
  v_mfma_f32_16x16x32_bf16 v[108:111], v[44:47], v[60:63], v[108:111]
  v_mfma_f32_16x16x32_bf16 v[112:115], v[44:47], v[64:67], v[112:115]
  ds_read_b64_tr_b16 v[44:45], v7 offset:63072
  ds_read_b64_tr_b16 v[46:47], v7 offset:64224
  v_mfma_f32_16x16x32_bf16 v[116:119], v[48:51], v[60:63], v[116:119]
  v_mfma_f32_16x16x32_bf16 v[120:123], v[48:51], v[64:67], v[120:123]
  ds_read_b64_tr_b16 v[48:49], v7 offset:63104
  ds_read_b64_tr_b16 v[50:51], v7 offset:64256
  s_waitcnt lgkmcnt(15)
  v_mfma_f32_16x16x32_bf16 v[84:87], v[12:15], v[68:71], v[84:87]
  v_mfma_f32_16x16x32_bf16 v[88:91], v[12:15], v[72:75], v[88:91]
  v_mfma_f32_16x16x32_bf16 v[92:95], v[16:19], v[68:71], v[92:95]
  v_mfma_f32_16x16x32_bf16 v[96:99], v[16:19], v[72:75], v[96:99]
  s_waitcnt lgkmcnt(14)
  v_mfma_f32_16x16x32_bf16 v[100:103], v[20:23], v[68:71], v[100:103]
  v_mfma_f32_16x16x32_bf16 v[104:107], v[20:23], v[72:75], v[104:107]
  s_waitcnt lgkmcnt(12)
  v_mfma_f32_16x16x32_bf16 v[108:111], v[24:27], v[68:71], v[108:111]
  v_mfma_f32_16x16x32_bf16 v[112:115], v[24:27], v[72:75], v[112:115]
  s_waitcnt lgkmcnt(10)
  v_mfma_f32_16x16x32_bf16 v[116:119], v[28:31], v[68:71], v[116:119]
  v_mfma_f32_16x16x32_bf16 v[120:123], v[28:31], v[72:75], v[120:123]
  s_waitcnt lgkmcnt(8)
  v_mfma_f32_16x16x32_bf16 v[84:87], v[32:35], v[76:79], v[84:87]
  v_mfma_f32_16x16x32_bf16 v[88:91], v[32:35], v[80:83], v[88:91]
  s_waitcnt lgkmcnt(6)
  v_mfma_f32_16x16x32_bf16 v[92:95], v[36:39], v[76:79], v[92:95]
  v_mfma_f32_16x16x32_bf16 v[96:99], v[36:39], v[80:83], v[96:99]
  s_waitcnt lgkmcnt(4)
  v_mfma_f32_16x16x32_bf16 v[100:103], v[40:43], v[76:79], v[100:103]
  v_mfma_f32_16x16x32_bf16 v[104:107], v[40:43], v[80:83], v[104:107]
  s_waitcnt lgkmcnt(2)
  v_mfma_f32_16x16x32_bf16 v[108:111], v[44:47], v[76:79], v[108:111]
  v_mfma_f32_16x16x32_bf16 v[112:115], v[44:47], v[80:83], v[112:115]
  s_waitcnt lgkmcnt(0)
  v_mfma_f32_16x16x32_bf16 v[116:119], v[48:51], v[76:79], v[116:119]
  v_mfma_f32_16x16x32_bf16 v[120:123], v[48:51], v[80:83], v[120:123]
  s_nop 7
  v_cvt_pk_bf16_f32 v84, v84, v85
  v_cvt_pk_bf16_f32 v85, v86, v87
  v_cvt_pk_bf16_f32 v86, v88, v89
  v_cvt_pk_bf16_f32 v87, v90, v91
  buffer_store_dwordx4 v[84:87], v140, s[28:31], s40 offen offset:0 sc1
  v_cvt_pk_bf16_f32 v92, v92, v93
  v_cvt_pk_bf16_f32 v93, v94, v95
  v_cvt_pk_bf16_f32 v94, v96, v97
  v_cvt_pk_bf16_f32 v95, v98, v99
  buffer_store_dwordx4 v[92:95], v140, s[28:31], s40 offen offset:1024 sc1
  v_cvt_pk_bf16_f32 v100, v100, v101
  v_cvt_pk_bf16_f32 v101, v102, v103
  v_cvt_pk_bf16_f32 v102, v104, v105
  v_cvt_pk_bf16_f32 v103, v106, v107
  buffer_store_dwordx4 v[100:103], v140, s[28:31], s40 offen offset:2048 sc1
  v_cvt_pk_bf16_f32 v108, v108, v109
  v_cvt_pk_bf16_f32 v109, v110, v111
  v_cvt_pk_bf16_f32 v110, v112, v113
  v_cvt_pk_bf16_f32 v111, v114, v115
  buffer_store_dwordx4 v[108:111], v140, s[28:31], s40 offen offset:3072 sc1
  s_add_u32 s40, s40, 4096
  v_cvt_pk_bf16_f32 v116, v116, v117
  v_cvt_pk_bf16_f32 v117, v118, v119
  v_cvt_pk_bf16_f32 v118, v120, v121
  v_cvt_pk_bf16_f32 v119, v122, v123
  buffer_store_dwordx4 v[116:119], v140, s[28:31], s40 offen offset:0 sc1
  s_branch L_k6_tail
L_k6_c1:
  s_barrier
  ds_read_b128 v[52:55], v5 offset:0
  ds_read_b128 v[56:59], v5 offset:256
  ds_read_b128 v[60:63], v5 offset:2048
  ds_read_b128 v[64:67], v5 offset:2304
  ds_read_b64_tr_b16 v[12:13], v7 offset:16384
  ds_read_b64_tr_b16 v[14:15], v7 offset:17536
  ds_read_b64_tr_b16 v[16:17], v7 offset:16416
  ds_read_b64_tr_b16 v[18:19], v7 offset:17568
  ds_read_b64_tr_b16 v[20:21], v7 offset:16448
  ds_read_b64_tr_b16 v[22:23], v7 offset:17600
  ds_read_b64_tr_b16 v[24:25], v7 offset:16480
  ds_read_b64_tr_b16 v[26:27], v7 offset:17632
  ds_read_b64_tr_b16 v[28:29], v7 offset:26112
  ds_read_b64_tr_b16 v[30:31], v7 offset:27264
  ds_read_b64_tr_b16 v[32:33], v7 offset:26144
  ds_read_b64_tr_b16 v[34:35], v7 offset:27296
  ds_read_b64_tr_b16 v[36:37], v7 offset:26176
  ds_read_b64_tr_b16 v[38:39], v7 offset:27328
  ds_read_b64_tr_b16 v[40:41], v7 offset:26208
  ds_read_b64_tr_b16 v[42:43], v7 offset:27360
  s_mov_b32 s41, 7
.p2align 6
L_k6_loop1:
  s_waitcnt lgkmcnt(14)
  v_mfma_f32_16x16x32_bf16 v[84:87], v[12:15], v[52:55], v[84:87]
  v_mfma_f32_16x16x32_bf16 v[88:91], v[12:15], v[56:59], v[88:91]
  s_waitcnt lgkmcnt(12)
  v_mfma_f32_16x16x32_bf16 v[92:95], v[16:19], v[52:55], v[92:95]
  v_mfma_f32_16x16x32_bf16 v[96:99], v[16:19], v[56:59], v[96:99]
  s_barrier
  ds_read_b128 v[68:71], v5 offset:36864
  ds_read_b128 v[72:75], v5 offset:37120
  ds_read_b128 v[76:79], v5 offset:38912
  ds_read_b128 v[80:83], v5 offset:39168
  ds_read_b64_tr_b16 v[12:13], v7 offset:53248
  ds_read_b64_tr_b16 v[14:15], v7 offset:54400
  ds_read_b64_tr_b16 v[16:17], v7 offset:53280
  ds_read_b64_tr_b16 v[18:19], v7 offset:54432
  s_waitcnt lgkmcnt(15)
  v_mfma_f32_16x16x32_bf16 v[100:103], v[20:23], v[52:55], v[100:103]
  v_mfma_f32_16x16x32_bf16 v[104:107], v[20:23], v[56:59], v[104:107]
  ds_read_b64_tr_b16 v[20:21], v7 offset:53312
  ds_read_b64_tr_b16 v[22:23], v7 offset:54464
  v_mfma_f32_16x16x32_bf16 v[108:111], v[24:27], v[52:55], v[108:111]
  v_mfma_f32_16x16x32_bf16 v[112:115], v[24:27], v[56:59], v[112:115]
  ds_read_b64_tr_b16 v[24:25], v7 offset:53344
  ds_read_b64_tr_b16 v[26:27], v7 offset:54496
  s_waitcnt lgkmcnt(15)
  v_mfma_f32_16x16x32_bf16 v[84:87], v[28:31], v[60:63], v[84:87]
  v_mfma_f32_16x16x32_bf16 v[88:91], v[28:31], v[64:67], v[88:91]
  ds_read_b64_tr_b16 v[28:29], v7 offset:62976
  ds_read_b64_tr_b16 v[30:31], v7 offset:64128
  v_mfma_f32_16x16x32_bf16 v[92:95], v[32:35], v[60:63], v[92:95]
  v_mfma_f32_16x16x32_bf16 v[96:99], v[32:35], v[64:67], v[96:99]
  ds_read_b64_tr_b16 v[32:33], v7 offset:63008
  ds_read_b64_tr_b16 v[34:35], v7 offset:64160
  s_waitcnt lgkmcnt(15)
  v_mfma_f32_16x16x32_bf16 v[100:103], v[36:39], v[60:63], v[100:103]
  v_mfma_f32_16x16x32_bf16 v[104:107], v[36:39], v[64:67], v[104:107]
  ds_read_b64_tr_b16 v[36:37], v7 offset:63040
  ds_read_b64_tr_b16 v[38:39], v7 offset:64192
  v_mfma_f32_16x16x32_bf16 v[108:111], v[40:43], v[60:63], v[108:111]
  v_mfma_f32_16x16x32_bf16 v[112:115], v[40:43], v[64:67], v[112:115]
  ds_read_b64_tr_b16 v[40:41], v7 offset:63072
  ds_read_b64_tr_b16 v[42:43], v7 offset:64224
  s_waitcnt lgkmcnt(14)
  v_mfma_f32_16x16x32_bf16 v[84:87], v[12:15], v[68:71], v[84:87]
  v_mfma_f32_16x16x32_bf16 v[88:91], v[12:15], v[72:75], v[88:91]
  s_waitcnt lgkmcnt(12)
  v_mfma_f32_16x16x32_bf16 v[92:95], v[16:19], v[68:71], v[92:95]
  v_mfma_f32_16x16x32_bf16 v[96:99], v[16:19], v[72:75], v[96:99]
  s_barrier
  ds_read_b128 v[52:55], v6 offset:0
  ds_read_b128 v[56:59], v6 offset:256
  ds_read_b128 v[60:63], v6 offset:2048
  ds_read_b128 v[64:67], v6 offset:2304
  ds_read_b64_tr_b16 v[12:13], v8 offset:16384
  ds_read_b64_tr_b16 v[14:15], v8 offset:17536
  ds_read_b64_tr_b16 v[16:17], v8 offset:16416
  ds_read_b64_tr_b16 v[18:19], v8 offset:17568
  s_waitcnt lgkmcnt(15)
  v_mfma_f32_16x16x32_bf16 v[100:103], v[20:23], v[68:71], v[100:103]
  v_mfma_f32_16x16x32_bf16 v[104:107], v[20:23], v[72:75], v[104:107]
  ds_read_b64_tr_b16 v[20:21], v8 offset:16448
  ds_read_b64_tr_b16 v[22:23], v8 offset:17600
  v_mfma_f32_16x16x32_bf16 v[108:111], v[24:27], v[68:71], v[108:111]
  v_mfma_f32_16x16x32_bf16 v[112:115], v[24:27], v[72:75], v[112:115]
  ds_read_b64_tr_b16 v[24:25], v8 offset:16480
  ds_read_b64_tr_b16 v[26:27], v8 offset:17632
  s_waitcnt lgkmcnt(15)
  v_mfma_f32_16x16x32_bf16 v[84:87], v[28:31], v[76:79], v[84:87]
  v_mfma_f32_16x16x32_bf16 v[88:91], v[28:31], v[80:83], v[88:91]
  ds_read_b64_tr_b16 v[28:29], v8 offset:26112
  ds_read_b64_tr_b16 v[30:31], v8 offset:27264
  v_mfma_f32_16x16x32_bf16 v[92:95], v[32:35], v[76:79], v[92:95]
  v_mfma_f32_16x16x32_bf16 v[96:99], v[32:35], v[80:83], v[96:99]
  ds_read_b64_tr_b16 v[32:33], v8 offset:26144
  ds_read_b64_tr_b16 v[34:35], v8 offset:27296
  s_waitcnt lgkmcnt(15)
  v_mfma_f32_16x16x32_bf16 v[100:103], v[36:39], v[76:79], v[100:103]
  v_mfma_f32_16x16x32_bf16 v[104:107], v[36:39], v[80:83], v[104:107]
  ds_read_b64_tr_b16 v[36:37], v8 offset:26176
  ds_read_b64_tr_b16 v[38:39], v8 offset:27328
  v_mfma_f32_16x16x32_bf16 v[108:111], v[40:43], v[76:79], v[108:111]
  v_mfma_f32_16x16x32_bf16 v[112:115], v[40:43], v[80:83], v[112:115]
  ds_read_b64_tr_b16 v[40:41], v8 offset:26208
  ds_read_b64_tr_b16 v[42:43], v8 offset:27360
  v_swap_b32 v5, v6
  v_swap_b32 v7, v8
  s_sub_u32 s41, s41, 1
  s_cmp_lg_u32 s41, 0
  s_cbranch_scc1 L_k6_loop1
  s_waitcnt lgkmcnt(14)
  v_mfma_f32_16x16x32_bf16 v[84:87], v[12:15], v[52:55], v[84:87]
  v_mfma_f32_16x16x32_bf16 v[88:91], v[12:15], v[56:59], v[88:91]
  s_waitcnt lgkmcnt(12)
  v_mfma_f32_16x16x32_bf16 v[92:95], v[16:19], v[52:55], v[92:95]
  v_mfma_f32_16x16x32_bf16 v[96:99], v[16:19], v[56:59], v[96:99]
  s_barrier
  ds_read_b128 v[68:71], v5 offset:36864
  ds_read_b128 v[72:75], v5 offset:37120
  ds_read_b128 v[76:79], v5 offset:38912
  ds_read_b128 v[80:83], v5 offset:39168
  ds_read_b64_tr_b16 v[12:13], v7 offset:53248
  ds_read_b64_tr_b16 v[14:15], v7 offset:54400
  ds_read_b64_tr_b16 v[16:17], v7 offset:53280
  ds_read_b64_tr_b16 v[18:19], v7 offset:54432
  s_waitcnt lgkmcnt(15)
  v_mfma_f32_16x16x32_bf16 v[100:103], v[20:23], v[52:55], v[100:103]
  v_mfma_f32_16x16x32_bf16 v[104:107], v[20:23], v[56:59], v[104:107]
  ds_read_b64_tr_b16 v[20:21], v7 offset:53312
  ds_read_b64_tr_b16 v[22:23], v7 offset:54464
  v_mfma_f32_16x16x32_bf16 v[108:111], v[24:27], v[52:55], v[108:111]
  v_mfma_f32_16x16x32_bf16 v[112:115], v[24:27], v[56:59], v[112:115]
  ds_read_b64_tr_b16 v[24:25], v7 offset:53344
  ds_read_b64_tr_b16 v[26:27], v7 offset:54496
  s_waitcnt lgkmcnt(15)
  v_mfma_f32_16x16x32_bf16 v[84:87], v[28:31], v[60:63], v[84:87]
  v_mfma_f32_16x16x32_bf16 v[88:91], v[28:31], v[64:67], v[88:91]
  ds_read_b64_tr_b16 v[28:29], v7 offset:62976
  ds_read_b64_tr_b16 v[30:31], v7 offset:64128
  v_mfma_f32_16x16x32_bf16 v[92:95], v[32:35], v[60:63], v[92:95]
  v_mfma_f32_16x16x32_bf16 v[96:99], v[32:35], v[64:67], v[96:99]
  ds_read_b64_tr_b16 v[32:33], v7 offset:63008
  ds_read_b64_tr_b16 v[34:35], v7 offset:64160
  s_waitcnt lgkmcnt(15)
  v_mfma_f32_16x16x32_bf16 v[100:103], v[36:39], v[60:63], v[100:103]
  v_mfma_f32_16x16x32_bf16 v[104:107], v[36:39], v[64:67], v[104:107]
  ds_read_b64_tr_b16 v[36:37], v7 offset:63040
  ds_read_b64_tr_b16 v[38:39], v7 offset:64192
  v_mfma_f32_16x16x32_bf16 v[108:111], v[40:43], v[60:63], v[108:111]
  v_mfma_f32_16x16x32_bf16 v[112:115], v[40:43], v[64:67], v[112:115]
  ds_read_b64_tr_b16 v[40:41], v7 offset:63072
  ds_read_b64_tr_b16 v[42:43], v7 offset:64224
  s_waitcnt lgkmcnt(14)
  v_mfma_f32_16x16x32_bf16 v[84:87], v[12:15], v[68:71], v[84:87]
  v_mfma_f32_16x16x32_bf16 v[88:91], v[12:15], v[72:75], v[88:91]
  s_waitcnt lgkmcnt(12)
  v_mfma_f32_16x16x32_bf16 v[92:95], v[16:19], v[68:71], v[92:95]
  v_mfma_f32_16x16x32_bf16 v[96:99], v[16:19], v[72:75], v[96:99]
  s_barrier
  ds_read_b128 v[52:55], v6 offset:0
  ds_read_b128 v[56:59], v6 offset:256
  ds_read_b128 v[60:63], v6 offset:2048
  ds_read_b128 v[64:67], v6 offset:2304
  ds_read_b64_tr_b16 v[12:13], v8 offset:16384
  ds_read_b64_tr_b16 v[14:15], v8 offset:17536
  ds_read_b64_tr_b16 v[16:17], v8 offset:16416
  ds_read_b64_tr_b16 v[18:19], v8 offset:17568
  s_waitcnt lgkmcnt(15)
  v_mfma_f32_16x16x32_bf16 v[100:103], v[20:23], v[68:71], v[100:103]
  v_mfma_f32_16x16x32_bf16 v[104:107], v[20:23], v[72:75], v[104:107]
  ds_read_b64_tr_b16 v[20:21], v8 offset:16448
  ds_read_b64_tr_b16 v[22:23], v8 offset:17600
  v_mfma_f32_16x16x32_bf16 v[108:111], v[24:27], v[68:71], v[108:111]
  v_mfma_f32_16x16x32_bf16 v[112:115], v[24:27], v[72:75], v[112:115]
  ds_read_b64_tr_b16 v[24:25], v8 offset:16480
  ds_read_b64_tr_b16 v[26:27], v8 offset:17632
  s_waitcnt lgkmcnt(15)
  v_mfma_f32_16x16x32_bf16 v[84:87], v[28:31], v[76:79], v[84:87]
  v_mfma_f32_16x16x32_bf16 v[88:91], v[28:31], v[80:83], v[88:91]
  ds_read_b64_tr_b16 v[28:29], v8 offset:26112
  ds_read_b64_tr_b16 v[30:31], v8 offset:27264
  v_mfma_f32_16x16x32_bf16 v[92:95], v[32:35], v[76:79], v[92:95]
  v_mfma_f32_16x16x32_bf16 v[96:99], v[32:35], v[80:83], v[96:99]
  ds_read_b64_tr_b16 v[32:33], v8 offset:26144
  ds_read_b64_tr_b16 v[34:35], v8 offset:27296
  s_waitcnt lgkmcnt(15)
  v_mfma_f32_16x16x32_bf16 v[100:103], v[36:39], v[76:79], v[100:103]
  v_mfma_f32_16x16x32_bf16 v[104:107], v[36:39], v[80:83], v[104:107]
  ds_read_b64_tr_b16 v[36:37], v8 offset:26176
  ds_read_b64_tr_b16 v[38:39], v8 offset:27328
  v_mfma_f32_16x16x32_bf16 v[108:111], v[40:43], v[76:79], v[108:111]
  v_mfma_f32_16x16x32_bf16 v[112:115], v[40:43], v[80:83], v[112:115]
  ds_read_b64_tr_b16 v[40:41], v8 offset:26208
  ds_read_b64_tr_b16 v[42:43], v8 offset:27360
  v_swap_b32 v5, v6
  v_swap_b32 v7, v8
  s_waitcnt lgkmcnt(14)
  v_mfma_f32_16x16x32_bf16 v[84:87], v[12:15], v[52:55], v[84:87]
  v_mfma_f32_16x16x32_bf16 v[88:91], v[12:15], v[56:59], v[88:91]
  s_waitcnt lgkmcnt(12)
  v_mfma_f32_16x16x32_bf16 v[92:95], v[16:19], v[52:55], v[92:95]
  v_mfma_f32_16x16x32_bf16 v[96:99], v[16:19], v[56:59], v[96:99]
  ds_read_b128 v[68:71], v5 offset:36864
  ds_read_b128 v[72:75], v5 offset:37120
  ds_read_b128 v[76:79], v5 offset:38912
  ds_read_b128 v[80:83], v5 offset:39168
  ds_read_b64_tr_b16 v[12:13], v7 offset:53248
  ds_read_b64_tr_b16 v[14:15], v7 offset:54400
  ds_read_b64_tr_b16 v[16:17], v7 offset:53280
  ds_read_b64_tr_b16 v[18:19], v7 offset:54432
  s_waitcnt lgkmcnt(15)
  v_mfma_f32_16x16x32_bf16 v[100:103], v[20:23], v[52:55], v[100:103]
  v_mfma_f32_16x16x32_bf16 v[104:107], v[20:23], v[56:59], v[104:107]
  ds_read_b64_tr_b16 v[20:21], v7 offset:53312
  ds_read_b64_tr_b16 v[22:23], v7 offset:54464
  v_mfma_f32_16x16x32_bf16 v[108:111], v[24:27], v[52:55], v[108:111]
  v_mfma_f32_16x16x32_bf16 v[112:115], v[24:27], v[56:59], v[112:115]
  ds_read_b64_tr_b16 v[24:25], v7 offset:53344
  ds_read_b64_tr_b16 v[26:27], v7 offset:54496
  s_waitcnt lgkmcnt(15)
  v_mfma_f32_16x16x32_bf16 v[84:87], v[28:31], v[60:63], v[84:87]
  v_mfma_f32_16x16x32_bf16 v[88:91], v[28:31], v[64:67], v[88:91]
  ds_read_b64_tr_b16 v[28:29], v7 offset:62976
  ds_read_b64_tr_b16 v[30:31], v7 offset:64128
  v_mfma_f32_16x16x32_bf16 v[92:95], v[32:35], v[60:63], v[92:95]
  v_mfma_f32_16x16x32_bf16 v[96:99], v[32:35], v[64:67], v[96:99]
  ds_read_b64_tr_b16 v[32:33], v7 offset:63008
  ds_read_b64_tr_b16 v[34:35], v7 offset:64160
  s_waitcnt lgkmcnt(15)
  v_mfma_f32_16x16x32_bf16 v[100:103], v[36:39], v[60:63], v[100:103]
  v_mfma_f32_16x16x32_bf16 v[104:107], v[36:39], v[64:67], v[104:107]
  ds_read_b64_tr_b16 v[36:37], v7 offset:63040
  ds_read_b64_tr_b16 v[38:39], v7 offset:64192
  v_mfma_f32_16x16x32_bf16 v[108:111], v[40:43], v[60:63], v[108:111]
  v_mfma_f32_16x16x32_bf16 v[112:115], v[40:43], v[64:67], v[112:115]
  ds_read_b64_tr_b16 v[40:41], v7 offset:63072
  ds_read_b64_tr_b16 v[42:43], v7 offset:64224
  s_waitcnt lgkmcnt(14)
  v_mfma_f32_16x16x32_bf16 v[84:87], v[12:15], v[68:71], v[84:87]
  v_mfma_f32_16x16x32_bf16 v[88:91], v[12:15], v[72:75], v[88:91]
  s_waitcnt lgkmcnt(12)
  v_mfma_f32_16x16x32_bf16 v[92:95], v[16:19], v[68:71], v[92:95]
  v_mfma_f32_16x16x32_bf16 v[96:99], v[16:19], v[72:75], v[96:99]
  s_waitcnt lgkmcnt(10)
  v_mfma_f32_16x16x32_bf16 v[100:103], v[20:23], v[68:71], v[100:103]
  v_mfma_f32_16x16x32_bf16 v[104:107], v[20:23], v[72:75], v[104:107]
  s_waitcnt lgkmcnt(8)
  v_mfma_f32_16x16x32_bf16 v[108:111], v[24:27], v[68:71], v[108:111]
  v_mfma_f32_16x16x32_bf16 v[112:115], v[24:27], v[72:75], v[112:115]
  s_waitcnt lgkmcnt(6)
  v_mfma_f32_16x16x32_bf16 v[84:87], v[28:31], v[76:79], v[84:87]
  v_mfma_f32_16x16x32_bf16 v[88:91], v[28:31], v[80:83], v[88:91]
  s_waitcnt lgkmcnt(4)
  v_mfma_f32_16x16x32_bf16 v[92:95], v[32:35], v[76:79], v[92:95]
  v_mfma_f32_16x16x32_bf16 v[96:99], v[32:35], v[80:83], v[96:99]
  s_waitcnt lgkmcnt(2)
  v_mfma_f32_16x16x32_bf16 v[100:103], v[36:39], v[76:79], v[100:103]
  v_mfma_f32_16x16x32_bf16 v[104:107], v[36:39], v[80:83], v[104:107]
  s_waitcnt lgkmcnt(0)
  v_mfma_f32_16x16x32_bf16 v[108:111], v[40:43], v[76:79], v[108:111]
  v_mfma_f32_16x16x32_bf16 v[112:115], v[40:43], v[80:83], v[112:115]
  s_nop 7
  v_cvt_pk_bf16_f32 v84, v84, v85
  v_cvt_pk_bf16_f32 v85, v86, v87
  v_cvt_pk_bf16_f32 v86, v88, v89
  v_cvt_pk_bf16_f32 v87, v90, v91
  buffer_store_dwordx4 v[84:87], v140, s[28:31], s40 offen offset:0 sc1
  v_cvt_pk_bf16_f32 v92, v92, v93
  v_cvt_pk_bf16_f32 v93, v94, v95
  v_cvt_pk_bf16_f32 v94, v96, v97
  v_cvt_pk_bf16_f32 v95, v98, v99
  buffer_store_dwordx4 v[92:95], v140, s[28:31], s40 offen offset:1024 sc1
  v_cvt_pk_bf16_f32 v100, v100, v101
  v_cvt_pk_bf16_f32 v101, v102, v103
  v_cvt_pk_bf16_f32 v102, v104, v105
  v_cvt_pk_bf16_f32 v103, v106, v107
  buffer_store_dwordx4 v[100:103], v140, s[28:31], s40 offen offset:2048 sc1
  v_cvt_pk_bf16_f32 v108, v108, v109
  v_cvt_pk_bf16_f32 v109, v110, v111
  v_cvt_pk_bf16_f32 v110, v112, v113
  v_cvt_pk_bf16_f32 v111, v114, v115
  buffer_store_dwordx4 v[108:111], v140, s[28:31], s40 offen offset:3072 sc1
  s_add_u32 s40, s40, 4096
L_k6_tail:
  s_mov_b32 s52, s12
  s_mov_b32 s53, s13
  s_mov_b32 s54, 2359296
  s_mov_b32 s55, 0x20000
  s_add_u32 s28, s20, 6397952
  s_addc_u32 s29, s21, 0
  s_mov_b32 s30, 2359296
  s_mov_b32 s31, 0x20000
  s_add_u32 s32, s20, 11520
  s_addc_u32 s33, s21, 0
  s_mov_b32 s34, 2304
  s_mov_b32 s35, 0x20000
  s_add_u32 s36, s20, 30056448
  s_addc_u32 s37, s21, 0
  s_mov_b32 s38, 18874368
  s_mov_b32 s39, 0x20000
  s_add_u32 s44, s20, 48930816
  s_addc_u32 s45, s21, 0
  s_mov_b32 s46, 16384
  s_mov_b32 s47, 0x20000
  s_waitcnt vmcnt(0)
  s_barrier
  s_lshl_b32 s40, s22, 2
  s_add_u32 s40, s40, s23
  s_lshl_b32 s48, s40, 8
  s_cmp_lg_u32 s3, 0
  s_cbranch_scc1 L_k6_w
  v_mov_b32 v0, 0
  v_mov_b32 v1, 1
  s_lshl_b32 s49, s24, 2
  v_mov_b32 v2, s49
  s_mov_b64 exec, 1
  buffer_store_dword v1, v2, s[44:47], s48 offen sc1
  s_mov_b64 exec, -1
L_k6_w:
  s_lshl_b32 s40, s40, 2
  s_add_u32 s40, s40, s24
  s_mul_i32 s40, s40, 9
  s_add_u32 s40, s40, s3
  s_lshl_b32 s40, s40, 10
  s_lshl_b32 s41, s22, 2
  s_add_u32 s41, s41, s24
  s_mul_i32 s41, s41, 36864
  s_mul_i32 s42, s23, 144
  s_lshl_b32 s43, s3, 4
  s_add_u32 s42, s42, s43
  s_lshl_b32 s43, s42, 1
  s_add_u32 s41, s41, s43
  s_add_u32 s43, s41, 18432
  s_lshl_b32 s42, s42, 2
  v_lshlrev_b32 v4, 4, v136
  v_mul_u32_u24 v5, 1152, v137
  v_lshl_add_u32 v5, v138, 3, v5
  v_lshlrev_b32 v6, 4, v138
  s_cmp_ge_u32 s3, 9
  s_cbranch_scc1 L_k6_nox
  buffer_load_dwordx2 v[40:41], v5, s[28:31], s41 offen
  buffer_load_dwordx2 v[42:43], v5, s[28:31], s43 offen
  buffer_load_dwordx4 v[44:47], v6, s[32:35], s42 offen
L_k6_nox:
  s_cmp_lg_u32 s3, 0
  s_cbranch_scc1 L_k6_go
  s_mov_b32 s49, 0
L_k6_poll:
  buffer_load_dwordx4 v[60:63], v0, s[44:47], s48 offen sc1
  s_waitcnt vmcnt(0)
  v_add3_u32 v1, v60, v61, v62
  v_add_u32 v1, v1, v63
  s_nop 0
  v_readfirstlane_b32 s50, v1
  s_add_u32 s49, s49, 1
  s_cmp_eq_u32 s50, 4
  s_cbranch_scc1 L_k6_go
  s_sleep 2
  s_cmp_lt_u32 s49, 0x100000
  s_cbranch_scc1 L_k6_poll
L_k6_go:
  s_barrier
  s_cmp_ge_u32 s3, 9
  s_cbranch_scc1 L_k6_end
  buffer_load_dwordx4 v[24:27], v4, s[36:39], s40 offen sc1
  s_add_u32 s40, s40, 2359296
  buffer_load_dwordx4 v[28:31], v4, s[36:39], s40 offen sc1
  s_add_u32 s40, s40, 2359296
  buffer_load_dwordx4 v[32:35], v4, s[36:39], s40 offen sc1
  s_add_u32 s40, s40, 2359296
  buffer_load_dwordx4 v[36:39], v4, s[36:39], s40 offen sc1
  s_waitcnt vmcnt(3)
  v_lshlrev_b32 v8, 16, v24
  v_and_b32 v9, 0xffff0000, v24
  v_lshlrev_b32 v10, 16, v25
  v_and_b32 v11, 0xffff0000, v25
  v_lshlrev_b32 v12, 16, v26
  v_and_b32 v13, 0xffff0000, v26
  v_lshlrev_b32 v14, 16, v27
  v_and_b32 v15, 0xffff0000, v27
  s_waitcnt vmcnt(2)
  v_lshlrev_b32 v52, 16, v28
  v_and_b32 v53, 0xffff0000, v28
  v_add_f32 v8, v8, v52
  v_add_f32 v9, v9, v53
  v_lshlrev_b32 v52, 16, v29
  v_and_b32 v53, 0xffff0000, v29
  v_add_f32 v10, v10, v52
  v_add_f32 v11, v11, v53
  v_lshlrev_b32 v52, 16, v30
  v_and_b32 v53, 0xffff0000, v30
  v_add_f32 v12, v12, v52
  v_add_f32 v13, v13, v53
  v_lshlrev_b32 v52, 16, v31
  v_and_b32 v53, 0xffff0000, v31
  v_add_f32 v14, v14, v52
  v_add_f32 v15, v15, v53
  s_waitcnt vmcnt(1)
  v_lshlrev_b32 v52, 16, v32
  v_and_b32 v53, 0xffff0000, v32
  v_add_f32 v8, v8, v52
  v_add_f32 v9, v9, v53
  v_lshlrev_b32 v52, 16, v33
  v_and_b32 v53, 0xffff0000, v33
  v_add_f32 v10, v10, v52
  v_add_f32 v11, v11, v53
  v_lshlrev_b32 v52, 16, v34
  v_and_b32 v53, 0xffff0000, v34
  v_add_f32 v12, v12, v52
  v_add_f32 v13, v13, v53
  v_lshlrev_b32 v52, 16, v35
  v_and_b32 v53, 0xffff0000, v35
  v_add_f32 v14, v14, v52
  v_add_f32 v15, v15, v53
  s_waitcnt vmcnt(0)
  v_lshlrev_b32 v52, 16, v36
  v_and_b32 v53, 0xffff0000, v36
  v_add_f32 v8, v8, v52
  v_add_f32 v9, v9, v53
  v_lshlrev_b32 v52, 16, v37
  v_and_b32 v53, 0xffff0000, v37
  v_add_f32 v10, v10, v52
  v_add_f32 v11, v11, v53
  v_lshlrev_b32 v52, 16, v38
  v_and_b32 v53, 0xffff0000, v38
  v_add_f32 v12, v12, v52
  v_add_f32 v13, v13, v53
  v_lshlrev_b32 v52, 16, v39
  v_and_b32 v53, 0xffff0000, v39
  v_add_f32 v14, v14, v52
  v_add_f32 v15, v15, v53
  v_lshlrev_b32 v52, 16, v40
  v_and_b32 v53, 0xffff0000, v40
  v_fmac_f32 v52, v44, v8
  v_fmac_f32 v53, v45, v9
  v_cvt_pk_bf16_f32 v56, v52, v53
  v_lshlrev_b32 v52, 16, v41
  v_and_b32 v53, 0xffff0000, v41
  v_fmac_f32 v52, v46, v10
  v_fmac_f32 v53, v47, v11
  v_cvt_pk_bf16_f32 v57, v52, v53
  v_lshlrev_b32 v52, 16, v42
  v_and_b32 v53, 0xffff0000, v42
  v_fmac_f32 v52, v44, v12
  v_fmac_f32 v53, v45, v13
  v_cvt_pk_bf16_f32 v58, v52, v53
  v_lshlrev_b32 v52, 16, v43
  v_and_b32 v53, 0xffff0000, v43
  v_fmac_f32 v52, v46, v14
  v_fmac_f32 v53, v47, v15
  v_cvt_pk_bf16_f32 v59, v52, v53
  buffer_store_dwordx2 v[56:57], v5, s[52:55], s41 offen
  buffer_store_dwordx2 v[58:59], v5, s[52:55], s43 offen
L_k6_end:
  s_endpgm
.section .rodata,"a"
.p2align 6
.amdhsa_kernel prep_kernel
  .amdhsa_next_free_vgpr 128
  .amdhsa_next_free_sgpr 102
  .amdhsa_accum_offset 128
  .amdhsa_group_segment_fixed_size 0
  .amdhsa_kernarg_size 112
  .amdhsa_user_sgpr_count 2
  .amdhsa_user_sgpr_kernarg_segment_ptr 1
  .amdhsa_system_sgpr_workgroup_id_x 1
.end_amdhsa_kernel
.p2align 6
.amdhsa_kernel qkv_kernel
  .amdhsa_next_free_vgpr 152
  .amdhsa_next_free_sgpr 102
  .amdhsa_accum_offset 152
  .amdhsa_group_segment_fixed_size 0
  .amdhsa_kernarg_size 112
  .amdhsa_user_sgpr_count 2
  .amdhsa_user_sgpr_kernarg_segment_ptr 1
  .amdhsa_system_sgpr_workgroup_id_x 1
.end_amdhsa_kernel
.p2align 6
.amdhsa_kernel attn_kernel
  .amdhsa_next_free_vgpr 168
  .amdhsa_next_free_sgpr 102
  .amdhsa_accum_offset 168
  .amdhsa_group_segment_fixed_size 0
  .amdhsa_kernarg_size 112
  .amdhsa_user_sgpr_count 2
  .amdhsa_user_sgpr_kernarg_segment_ptr 1
  .amdhsa_system_sgpr_workgroup_id_x 1
.end_amdhsa_kernel
.p2align 6
.amdhsa_kernel wo_kernel
  .amdhsa_next_free_vgpr 128
  .amdhsa_next_free_sgpr 102
  .amdhsa_accum_offset 128
  .amdhsa_group_segment_fixed_size 0
  .amdhsa_kernarg_size 112
  .amdhsa_user_sgpr_count 2
  .amdhsa_user_sgpr_kernarg_segment_ptr 1
  .amdhsa_system_sgpr_workgroup_id_x 1
.end_amdhsa_kernel
.p2align 6
.amdhsa_kernel ffn1_kernel
  .amdhsa_next_free_vgpr 168
  .amdhsa_next_free_sgpr 102
  .amdhsa_accum_offset 168
  .amdhsa_group_segment_fixed_size 0
  .amdhsa_kernarg_size 112
  .amdhsa_user_sgpr_count 2
  .amdhsa_user_sgpr_kernarg_segment_ptr 1
  .amdhsa_system_sgpr_workgroup_id_x 1
.end_amdhsa_kernel
.p2align 6
.amdhsa_kernel ffn2_kernel
  .amdhsa_next_free_vgpr 160
  .amdhsa_next_free_sgpr 102
  .amdhsa_accum_offset 160
  .amdhsa_group_segment_fixed_size 0
  .amdhsa_kernarg_size 112
  .amdhsa_user_sgpr_count 2
  .amdhsa_user_sgpr_kernarg_segment_ptr 1
  .amdhsa_system_sgpr_workgroup_id_x 1
.end_amdhsa_kernel
```
